```python
import torch

def _softmax(x, axis=-1):
    return torch.softmax(x, dim=axis)
def _gelu(x):
    return torch.nn.functional.gelu(x, approximate="tanh")
def _silu(x):
    return torch.nn.functional.silu(x)
def _sigmoid(x):
    return torch.sigmoid(x)
def _layernorm(x, axis=-1, eps=1e-5):
    m = x.mean(dim=axis, keepdim=True)
    v = x.var(dim=axis, keepdim=True, unbiased=False)
    return (x - m) / torch.sqrt(v + eps)
def _scatter_add(tgt, idx, src, axis=0):
    return tgt.clone().index_add_(axis, idx, src)
def _segment_sum(src, seg, n):
    out = torch.zeros((n,) + src.shape[1:], dtype=src.dtype)
    return out.index_add_(0, seg, src)
def _pad(x, pw):
    flat = tuple(v for pair in reversed(pw) for v in pair)
    return torch.nn.functional.pad(x, flat)

kernel_name = 'parallel_sum__ssm_conv_s4__dense_activation_gelu__prompt'

def setup_inputs():

    _w = (lambda a: (lambda t: t.to(torch.bfloat16) if t.is_floating_point() else t)(torch.as_tensor(a)))
    def _A_setup():
        B, L, D, N = 1, 2048, 448, 256
        A_re = -(lambda _x: torch.exp(torch.as_tensor(_x)))((lambda *s: torch.randn(*s, dtype=torch.bfloat16) * 6.4)(D, N))
        A_im = torch.pi * (lambda *s: torch.randn(*s, dtype=torch.bfloat16) * 0.05)(D, N)
        B_re = (lambda *s: torch.randn(*s, dtype=torch.bfloat16) * 0.1)(D, N)
        B_im = (lambda *s: torch.randn(*s, dtype=torch.bfloat16) * 0.1)(D, N)
        C_re = (lambda *s: torch.randn(*s, dtype=torch.bfloat16) * 0.1)(D, N)
        C_im = (lambda *s: torch.randn(*s, dtype=torch.bfloat16) * 0.1)(D, N)
        log_dt = (lambda *s: torch.randn(*s, dtype=torch.bfloat16) * 0.05)(D) * 0.5 - 4.0
        Dskip = (lambda *s: torch.randn(*s, dtype=torch.bfloat16) * 0.05)(D)
        return {
            "u": _w((lambda *s: torch.randn(*s, dtype=torch.bfloat16) * 0.05)(B, L, D)),
            "A_re": _w(A_re),
            "A_im": _w(A_im),
            "B_re": _w(B_re),
            "B_im": _w(B_im),
            "C_re": _w(C_re),
            "C_im": _w(C_im),
            "log_dt": _w(log_dt),
            "Dskip": _w(Dskip),
        }
    _A_in = _A_setup()

    def _B_setup():
        B, S, D, F = 1, 2048, 448, 1792
        return {
            "x": _w((lambda *s: torch.randn(*s, dtype=torch.bfloat16) * 0.05)(B, S, D)),
            "w1": _w((lambda *s: torch.randn(*s, dtype=torch.bfloat16) * 0.8)(D, F) * (D ** -0.5)),
            "b1": _w((lambda *s: torch.randn(*s, dtype=torch.bfloat16) * 0.2)(F) * 0.01),
            "w2": _w((lambda *s: torch.randn(*s, dtype=torch.bfloat16) * 0.2)(F, D) * (F ** -0.5)),
            "b2": _w((lambda *s: torch.randn(*s, dtype=torch.bfloat16) * 0.2)(D) * 0.01),
        }
    _B_in = _B_setup()

    return {
        "A_u": _A_in["u"],
        "A_A_re": _A_in["A_re"],
        "A_A_im": _A_in["A_im"],
        "A_B_re": _A_in["B_re"],
        "A_B_im": _A_in["B_im"],
        "A_C_re": _A_in["C_re"],
        "A_C_im": _A_in["C_im"],
        "A_log_dt": _A_in["log_dt"],
        "A_Dskip": _A_in["Dskip"],
        "B_x": _B_in["x"],
        "B_w1": _B_in["w1"],
        "B_b1": _B_in["b1"],
        "B_w2": _B_in["w2"],
        "B_b2": _B_in["b2"],
    }

def reference(A_u, A_A_re, A_A_im, A_B_re, A_B_im, A_C_re, A_C_im, A_log_dt, A_Dskip, B_x, B_w1, B_b1, B_w2, B_b2):
    def _A_ref(u, A_re, A_im, B_re, B_im, C_re, C_im, log_dt, Dskip):
        Bsz, L, D = u.shape
        dt = torch.exp(log_dt)[:, None]
        A = A_re + 1j * A_im
        Bc = B_re + 1j * B_im
        Cc = C_re + 1j * C_im
        logdA = dt * A
        dB = dt * Bc
        l = (lambda x, dt: x.to(dt))(torch.arange(L), A_re.dtype)
        P = torch.exp(logdA[:, :, None] * l[None, None, :])
        K = torch.einsum("dn,dnl,dn->dl", Cc, P, dB).real
        L2 = 2 * L
        Kp = _pad(K, ((0, 0), (0, L)))
        up = (lambda x, *d: x.permute(*d))(u, 0, 2, 1)
        up = _pad(up, ((0, 0), (0, 0), (0, L)))
        Kf = (lambda x, axes=(-2,-1): torch.fft.rfft2(x.float(), dim=axes))(Kp[:, None, :], axes=(-2, -1))
        Uf = (lambda x, axes=(-2,-1): torch.fft.rfft2(x.float(), dim=axes))(up[:, :, None, :], axes=(-2, -1))
        Yf = Uf * Kf[None, :, :, :]
        y = (lambda x, s, axes=(-2,-1): torch.fft.irfft2(x, s=s, dim=axes).to(torch.bfloat16))(Yf, (1, L2), axes=(-2, -1))[:, :, 0, :L]
        y = (lambda x, *d: x.permute(*d))(y, 0, 2, 1) + u * Dskip[None, None, :]
        return y

    def _B_ref(x, w1, b1, w2, b2):
        h = torch.einsum("bsd,df->bsf", x, w1) + b1
        h = _gelu(h)
        return torch.einsum("bsf,fd->bsd", h, w2) + b2

    x = A_u
    xn = _layernorm(x, axis=-1)
    return x + _A_ref(xn, A_A_re, A_A_im, A_B_re, A_B_im, A_C_re, A_C_im, A_log_dt, A_Dskip) + _B_ref(xn, B_w1, B_b1, B_w2, B_b2)
```

```asm
; @launch grid=(512,1,1) block=(256,1,1) lds=81920
.amdgcn_target "amdgcn-amd-amdhsa--gfx950"
.text
.globl parallel_sum__ssm_conv_s4__dense_activation_gelu__prompt_kernel
.p2align 8
.type parallel_sum__ssm_conv_s4__dense_activation_gelu__prompt_kernel,@function
parallel_sum__ssm_conv_s4__dense_activation_gelu__prompt_kernel:
    s_cmp_ge_u32 s2, 512
    s_cbranch_scc1 M_END
    s_cmp_ge_u32 s2, 288
    s_cbranch_scc1 R_G
    s_cmp_ge_u32 s2, 284
    s_cbranch_scc1 M_END
    s_cmp_ge_u32 s2, 256
    s_cbranch_scc1 R_CS
    s_cmp_ge_u32 s2, 32
    s_cbranch_scc1 R_AUX
R_LN:
    s_setprio 2
    s_load_dwordx2 s[20:21], s[0:1], 0
    s_load_dwordx2 s[22:23], s[0:1], 128
    s_load_dwordx2 s[24:25], s[0:1], 120
    s_memrealtime s[26:27]
    v_lshrrev_b32 v2, 6, v0
    v_and_b32 v1, 63, v0
    v_readfirstlane_b32 s30, v2
    v_lshrrev_b32 v7, 2, v1
    v_and_b32 v8, 3, v1
    s_lshl_b32 s31, s2, 6
    s_lshl_b32 s32, s30, 4
    s_add_u32 s31, s31, s32
    v_add_u32 v2, s31, v7
    v_mul_u32_u24 v2, 896, v2
    v_lshl_add_u32 v6, v8, 4, v2
    s_waitcnt lgkmcnt(0)
    s_mov_b32 s4, s20
    s_and_b32 s5, s21, 0xffff
    s_mov_b32 s6, 1835008
    s_mov_b32 s7, 0x20000
    s_mov_b32 s12, s24
    s_and_b32 s13, s25, 0xffff
    s_mov_b32 s14, 256
    s_mov_b32 s15, 0x20000
    s_or_b32 s32, s2, s30
    s_cmp_lg_u32 s32, 0
    s_cbranch_scc1 LN_nn_1
    s_or_b32 s26, s26, 1
    v_mov_b32 v10, s26
    v_mov_b32 v11, s27
    v_mov_b32 v12, 0
    buffer_store_dwordx2 v[10:11], v12, s[12:15], 0 offen sc1
    s_nop 1
LN_nn_1:
    buffer_load_dwordx4 v[16:19], v6, s[4:7], 0 offen offset:0
    buffer_load_dwordx4 v[20:23], v6, s[4:7], 0 offen offset:64
    buffer_load_dwordx4 v[24:27], v6, s[4:7], 0 offen offset:128
    buffer_load_dwordx4 v[28:31], v6, s[4:7], 0 offen offset:192
    buffer_load_dwordx4 v[32:35], v6, s[4:7], 0 offen offset:256
    buffer_load_dwordx4 v[36:39], v6, s[4:7], 0 offen offset:320
    buffer_load_dwordx4 v[40:43], v6, s[4:7], 0 offen offset:384
    buffer_load_dwordx4 v[44:47], v6, s[4:7], 0 offen offset:448
    buffer_load_dwordx4 v[48:51], v6, s[4:7], 0 offen offset:512
    buffer_load_dwordx4 v[52:55], v6, s[4:7], 0 offen offset:576
    buffer_load_dwordx4 v[56:59], v6, s[4:7], 0 offen offset:640
    buffer_load_dwordx4 v[60:63], v6, s[4:7], 0 offen offset:704
    buffer_load_dwordx4 v[64:67], v6, s[4:7], 0 offen offset:768
    buffer_load_dwordx4 v[68:71], v6, s[4:7], 0 offen offset:832
    v_mov_b32 v12, 0
    buffer_load_dwordx2 v[10:11], v12, s[12:15], 0 offen sc1
    s_mov_b32 s8, s22
    s_and_b32 s9, s23, 0xffff
    s_mov_b32 s10, 13631488
    s_mov_b32 s11, 0x20000
    s_mov_b32 s37, 0x3f803f80
    v_mov_b32 v72, 0
    v_mov_b32 v73, 0
    v_mov_b32 v74, 0
    v_mov_b32 v75, 0
    s_lshl_b32 s32, s30, 4
    v_add_u32 v2, s32, v7
    v_mul_u32_u24 v2, 912, v2
    v_lshl_add_u32 v76, v8, 4, v2
    s_waitcnt vmcnt(14)
    v_dot2c_f32_bf16 v74, v16, v16
    v_dot2c_f32_bf16 v72, s37, v16
    v_dot2c_f32_bf16 v75, v17, v17
    v_dot2c_f32_bf16 v73, s37, v17
    v_dot2c_f32_bf16 v74, v18, v18
    v_dot2c_f32_bf16 v72, s37, v18
    v_dot2c_f32_bf16 v75, v19, v19
    v_dot2c_f32_bf16 v73, s37, v19
    ds_write_b128 v76, v[16:19] offset:0
    s_waitcnt vmcnt(13)
    v_dot2c_f32_bf16 v74, v20, v20
    v_dot2c_f32_bf16 v72, s37, v20
    v_dot2c_f32_bf16 v75, v21, v21
    v_dot2c_f32_bf16 v73, s37, v21
    v_dot2c_f32_bf16 v74, v22, v22
    v_dot2c_f32_bf16 v72, s37, v22
    v_dot2c_f32_bf16 v75, v23, v23
    v_dot2c_f32_bf16 v73, s37, v23
    ds_write_b128 v76, v[20:23] offset:64
    s_waitcnt vmcnt(12)
    v_dot2c_f32_bf16 v74, v24, v24
    v_dot2c_f32_bf16 v72, s37, v24
    v_dot2c_f32_bf16 v75, v25, v25
    v_dot2c_f32_bf16 v73, s37, v25
    v_dot2c_f32_bf16 v74, v26, v26
    v_dot2c_f32_bf16 v72, s37, v26
    v_dot2c_f32_bf16 v75, v27, v27
    v_dot2c_f32_bf16 v73, s37, v27
    ds_write_b128 v76, v[24:27] offset:128
    s_waitcnt vmcnt(11)
    v_dot2c_f32_bf16 v74, v28, v28
    v_dot2c_f32_bf16 v72, s37, v28
    v_dot2c_f32_bf16 v75, v29, v29
    v_dot2c_f32_bf16 v73, s37, v29
    v_dot2c_f32_bf16 v74, v30, v30
    v_dot2c_f32_bf16 v72, s37, v30
    v_dot2c_f32_bf16 v75, v31, v31
    v_dot2c_f32_bf16 v73, s37, v31
    ds_write_b128 v76, v[28:31] offset:192
    buffer_load_dwordx2 v[78:79], v12, s[12:15], 0 offen sc1
    s_waitcnt vmcnt(11)
    v_dot2c_f32_bf16 v74, v32, v32
    v_dot2c_f32_bf16 v72, s37, v32
    v_dot2c_f32_bf16 v75, v33, v33
    v_dot2c_f32_bf16 v73, s37, v33
    v_dot2c_f32_bf16 v74, v34, v34
    v_dot2c_f32_bf16 v72, s37, v34
    v_dot2c_f32_bf16 v75, v35, v35
    v_dot2c_f32_bf16 v73, s37, v35
    ds_write_b128 v76, v[32:35] offset:256
    s_waitcnt vmcnt(10)
    v_dot2c_f32_bf16 v74, v36, v36
    v_dot2c_f32_bf16 v72, s37, v36
    v_dot2c_f32_bf16 v75, v37, v37
    v_dot2c_f32_bf16 v73, s37, v37
    v_dot2c_f32_bf16 v74, v38, v38
    v_dot2c_f32_bf16 v72, s37, v38
    v_dot2c_f32_bf16 v75, v39, v39
    v_dot2c_f32_bf16 v73, s37, v39
    ds_write_b128 v76, v[36:39] offset:320
    s_waitcnt vmcnt(9)
    v_dot2c_f32_bf16 v74, v40, v40
    v_dot2c_f32_bf16 v72, s37, v40
    v_dot2c_f32_bf16 v75, v41, v41
    v_dot2c_f32_bf16 v73, s37, v41
    v_dot2c_f32_bf16 v74, v42, v42
    v_dot2c_f32_bf16 v72, s37, v42
    v_dot2c_f32_bf16 v75, v43, v43
    v_dot2c_f32_bf16 v73, s37, v43
    ds_write_b128 v76, v[40:43] offset:384
    s_waitcnt vmcnt(8)
    v_dot2c_f32_bf16 v74, v44, v44
    v_dot2c_f32_bf16 v72, s37, v44
    v_dot2c_f32_bf16 v75, v45, v45
    v_dot2c_f32_bf16 v73, s37, v45
    v_dot2c_f32_bf16 v74, v46, v46
    v_dot2c_f32_bf16 v72, s37, v46
    v_dot2c_f32_bf16 v75, v47, v47
    v_dot2c_f32_bf16 v73, s37, v47
    ds_write_b128 v76, v[44:47] offset:448
    s_waitcnt vmcnt(7)
    v_dot2c_f32_bf16 v74, v48, v48
    v_dot2c_f32_bf16 v72, s37, v48
    v_dot2c_f32_bf16 v75, v49, v49
    v_dot2c_f32_bf16 v73, s37, v49
    v_dot2c_f32_bf16 v74, v50, v50
    v_dot2c_f32_bf16 v72, s37, v50
    v_dot2c_f32_bf16 v75, v51, v51
    v_dot2c_f32_bf16 v73, s37, v51
    ds_write_b128 v76, v[48:51] offset:512
    s_waitcnt vmcnt(6)
    v_dot2c_f32_bf16 v74, v52, v52
    v_dot2c_f32_bf16 v72, s37, v52
    v_dot2c_f32_bf16 v75, v53, v53
    v_dot2c_f32_bf16 v73, s37, v53
    v_dot2c_f32_bf16 v74, v54, v54
    v_dot2c_f32_bf16 v72, s37, v54
    v_dot2c_f32_bf16 v75, v55, v55
    v_dot2c_f32_bf16 v73, s37, v55
    ds_write_b128 v76, v[52:55] offset:576
    s_waitcnt vmcnt(5)
    v_dot2c_f32_bf16 v74, v56, v56
    v_dot2c_f32_bf16 v72, s37, v56
    v_dot2c_f32_bf16 v75, v57, v57
    v_dot2c_f32_bf16 v73, s37, v57
    v_dot2c_f32_bf16 v74, v58, v58
    v_dot2c_f32_bf16 v72, s37, v58
    v_dot2c_f32_bf16 v75, v59, v59
    v_dot2c_f32_bf16 v73, s37, v59
    ds_write_b128 v76, v[56:59] offset:640
    s_waitcnt vmcnt(4)
    v_dot2c_f32_bf16 v74, v60, v60
    v_dot2c_f32_bf16 v72, s37, v60
    v_dot2c_f32_bf16 v75, v61, v61
    v_dot2c_f32_bf16 v73, s37, v61
    v_dot2c_f32_bf16 v74, v62, v62
    v_dot2c_f32_bf16 v72, s37, v62
    v_dot2c_f32_bf16 v75, v63, v63
    v_dot2c_f32_bf16 v73, s37, v63
    ds_write_b128 v76, v[60:63] offset:704
    s_waitcnt vmcnt(3)
    v_dot2c_f32_bf16 v74, v64, v64
    v_dot2c_f32_bf16 v72, s37, v64
    v_dot2c_f32_bf16 v75, v65, v65
    v_dot2c_f32_bf16 v73, s37, v65
    v_dot2c_f32_bf16 v74, v66, v66
    v_dot2c_f32_bf16 v72, s37, v66
    v_dot2c_f32_bf16 v75, v67, v67
    v_dot2c_f32_bf16 v73, s37, v67
    ds_write_b128 v76, v[64:67] offset:768
    s_waitcnt vmcnt(2)
    v_dot2c_f32_bf16 v74, v68, v68
    v_dot2c_f32_bf16 v72, s37, v68
    v_dot2c_f32_bf16 v75, v69, v69
    v_dot2c_f32_bf16 v73, s37, v69
    v_dot2c_f32_bf16 v74, v70, v70
    v_dot2c_f32_bf16 v72, s37, v70
    v_dot2c_f32_bf16 v75, v71, v71
    v_dot2c_f32_bf16 v73, s37, v71
    ds_write_b128 v76, v[68:71] offset:832
    s_nop 3
    v_add_f32 v72, v72, v73
    v_add_f32 v74, v74, v75
    s_nop 1
    v_add_f32_dpp v72, v72, v72 quad_perm:[1,0,3,2] row_mask:0xf bank_mask:0xf
    v_add_f32_dpp v74, v74, v74 quad_perm:[1,0,3,2] row_mask:0xf bank_mask:0xf
    s_nop 1
    v_add_f32_dpp v72, v72, v72 quad_perm:[2,3,0,1] row_mask:0xf bank_mask:0xf
    v_add_f32_dpp v74, v74, v74 quad_perm:[2,3,0,1] row_mask:0xf bank_mask:0xf
    s_nop 1
    v_mul_f32 v72, 0x3b124925, v72
    v_mul_f32 v74, 0x3b124925, v74
    v_fma_f32 v74, -v72, v72, v74
    v_max_f32 v74, 0, v74
    v_cvt_pk_bf16_f32 v4, v72, v74
    v_lshlrev_b32 v72, 16, v4
    v_and_b32 v74, 0xffff0000, v4
    v_add_f32 v74, 0x3727c5ac, v74
    v_cvt_pk_bf16_f32 v74, v74, v74
    v_lshlrev_b32 v74, 16, v74
    v_sqrt_f32 v74, v74
    s_nop 0
    v_cvt_pk_bf16_f32 v74, v74, v74
    v_lshlrev_b32 v74, 16, v74
    v_rcp_f32 v81, v74
    s_nop 0
    v_mul_f32 v80, v72, v81
    s_waitcnt vmcnt(0)
    v_mov_b32 v10, v78
    v_mov_b32 v11, v79
    s_nop 0
    s_mov_b32 s33, 20000
NC_l_2:
    v_readfirstlane_b32 s26, v10
    v_readfirstlane_b32 s27, v11
    s_nop 1
    s_cmp_lg_u32 s26, 0
    s_cbranch_scc1 NC_ok_3
    s_sub_u32 s33, s33, 1
    s_cmp_eq_u32 s33, 0
    s_cbranch_scc1 NC_ok_3
    s_sleep 1
    buffer_load_dwordx2 v[10:11], v12, s[12:15], 0 offen sc1
    s_waitcnt vmcnt(0)
    s_branch NC_l_2
NC_ok_3:
    v_mov_b32 v82, s26
    v_mov_b32 v83, s27
    v_add_u32 v2, s31, v7
    v_lshlrev_b32 v2, 4, v2
    v_cmp_eq_u32 vcc, 0, v8
    v_mov_b32 v3, 0x7ff00000
    s_nop 0
    v_cndmask_b32 v2, v3, v2, vcc
    s_mov_b32 s34, 12722176
    buffer_store_dwordx4 v[80:83], v2, s[8:11], s34 offen sc1
    s_lshl_b32 s32, s30, 4
    v_add_u32 v2, s32, v7
    v_lshlrev_b32 v2, 3, v2
    ds_write_b64 v2, v[80:81] offset:58368
    s_waitcnt lgkmcnt(0)
    s_barrier
    v_lshrrev_b32 v2, 4, v1
    v_lshlrev_b32 v2, 6, v2
    ds_read_b128 v[84:87], v2 offset:58368
    ds_read_b128 v[88:91], v2 offset:58384
    ds_read_b128 v[92:95], v2 offset:58400
    ds_read_b128 v[96:99], v2 offset:58416
    ds_read_b128 v[100:103], v2 offset:58624
    ds_read_b128 v[104:107], v2 offset:58640
    ds_read_b128 v[108:111], v2 offset:58656
    ds_read_b128 v[112:115], v2 offset:58672
    v_lshrrev_b32 v2, 4, v1
    v_lshlrev_b32 v2, 3, v2
    v_bfe_u32 v3, v1, 2, 2
    v_add_u32 v2, v2, v3
    v_mul_u32_u24 v2, 912, v2
    v_and_b32 v3, 3, v1
    v_lshl_add_u32 v2, v3, 3, v2
    s_lshl_b32 s32, s30, 5
    v_add_u32 v116, s32, v2
    v_and_b32 v2, 15, v1
    v_and_b32 v3, 7, v1
    v_lshrrev_b32 v4, 4, v1
    v_xor_b32 v3, v3, v4
    v_lshlrev_b32 v3, 4, v3
    v_lshl_add_u32 v2, v2, 7, v3
    s_lshl_b32 s32, s30, 11
    s_add_u32 s32, s32, 58880
    v_add_u32 v118, s32, v2
    v_lshlrev_b32 v2, 4, v1
    v_add_u32 v119, s32, v2
    s_load_dwordx2 s[40:41], s[0:1], 112
    v_lshrrev_b32 v2, 3, v1
    v_and_b32 v3, 7, v1
    v_xor_b32 v3, v3, v2
    v_lshlrev_b32 v3, 4, v3
    s_lshl_b32 s33, s30, 4
    v_add_u32 v2, s33, v2
    v_mul_u32_u24 v2, 896, v2
    v_add_u32 v2, v2, v3
    s_mul_i32 s32, s2, 57344
    v_add_u32 v117, s32, v2
    v_add_u32 v120, 7168, v117
    s_waitcnt lgkmcnt(0)
    s_and_b32 s41, s41, 0xffff
    s_mov_b32 s42, 1835008
    s_mov_b32 s43, 0x20000
    s_mov_b32 s44, 7
    s_mov_b32 s45, 0
    ds_read_b64_tr_b16 v[130:131], v116 offset:0
    ds_read_b64_tr_b16 v[132:133], v116 offset:3648
    ds_read_b64_tr_b16 v[134:135], v116 offset:29184
    ds_read_b64_tr_b16 v[136:137], v116 offset:32832
LN_lp_4:
    s_waitcnt lgkmcnt(0)
    v_mov_b32 v122, v130
    v_mov_b32 v123, v131
    v_mov_b32 v124, v132
    v_mov_b32 v125, v133
    v_mov_b32 v126, v134
    v_mov_b32 v127, v135
    v_mov_b32 v128, v136
    v_mov_b32 v129, v137
    v_add_u32 v116, 128, v116
    ds_read_b64_tr_b16 v[130:131], v116 offset:0
    ds_read_b64_tr_b16 v[132:133], v116 offset:3648
    ds_read_b64_tr_b16 v[134:135], v116 offset:29184
    ds_read_b64_tr_b16 v[136:137], v116 offset:32832
    v_lshlrev_b32 v138, 16, v122
    v_and_b32 v139, 0xffff0000, v122
    v_lshlrev_b32 v140, 16, v123
    v_and_b32 v141, 0xffff0000, v123
    v_lshlrev_b32 v142, 16, v124
    v_and_b32 v143, 0xffff0000, v124
    v_lshlrev_b32 v144, 16, v125
    v_and_b32 v145, 0xffff0000, v125
    v_fma_f32 v138, v138, v85, -v84
    v_fma_f32 v139, v139, v87, -v86
    v_fma_f32 v140, v140, v89, -v88
    v_fma_f32 v141, v141, v91, -v90
    v_fma_f32 v142, v142, v93, -v92
    v_fma_f32 v143, v143, v95, -v94
    v_fma_f32 v144, v144, v97, -v96
    v_fma_f32 v145, v145, v99, -v98
    v_cvt_pk_bf16_f32 v146, v138, v139
    v_cvt_pk_bf16_f32 v147, v140, v141
    v_cvt_pk_bf16_f32 v148, v142, v143
    v_cvt_pk_bf16_f32 v149, v144, v145
    ds_write_b128 v118, v[146:149]
    v_lshlrev_b32 v138, 16, v126
    v_and_b32 v139, 0xffff0000, v126
    v_lshlrev_b32 v140, 16, v127
    v_and_b32 v141, 0xffff0000, v127
    v_lshlrev_b32 v142, 16, v128
    v_and_b32 v143, 0xffff0000, v128
    v_lshlrev_b32 v144, 16, v129
    v_and_b32 v145, 0xffff0000, v129
    v_fma_f32 v138, v138, v101, -v100
    v_fma_f32 v139, v139, v103, -v102
    v_fma_f32 v140, v140, v105, -v104
    v_fma_f32 v141, v141, v107, -v106
    v_fma_f32 v142, v142, v109, -v108
    v_fma_f32 v143, v143, v111, -v110
    v_fma_f32 v144, v144, v113, -v112
    v_fma_f32 v145, v145, v115, -v114
    v_cvt_pk_bf16_f32 v150, v138, v139
    v_cvt_pk_bf16_f32 v151, v140, v141
    v_cvt_pk_bf16_f32 v152, v142, v143
    v_cvt_pk_bf16_f32 v153, v144, v145
    v_xor_b32 v2, 64, v118
    ds_write_b128 v2, v[150:153]
    ds_read_b128 v[154:157], v119
    ds_read_b128 v[158:161], v119 offset:1024
    s_waitcnt lgkmcnt(0)
    buffer_store_dwordx4 v[154:157], v117, s[40:43], s45 offen sc1
    buffer_store_dwordx4 v[158:161], v120, s[40:43], s45 offen sc1
    s_add_u32 s45, s45, 128
    s_sub_u32 s44, s44, 1
    s_cmp_lg_u32 s44, 0
    s_cbranch_scc1 LN_lp_4
    s_waitcnt vmcnt(0)
    s_barrier
    s_lshl_b32 s32, s2, 3
    s_add_u32 s32, s32, 12716288
    s_cmp_lg_u32 s30, 0
    s_cbranch_scc1 FL_s_5
    v_mov_b32 v2, s26
    v_mov_b32 v3, s27
    v_cmp_eq_u32 vcc, 0, v1
    v_mov_b32 v4, 0x7ff00000
    v_mov_b32 v5, 0
    s_nop 0
    v_cndmask_b32 v4, v4, v5, vcc
    buffer_store_dwordx2 v[2:3], v4, s[8:11], s32 offen sc1
FL_s_5:
    s_waitcnt vmcnt(0)
    s_branch M_END
R_CS:
    s_setprio 2
    s_load_dwordx2 s[20:21], s[0:1], 80
    s_load_dwordx2 s[22:23], s[0:1], 128
    s_load_dwordx2 s[24:25], s[0:1], 120
    v_lshrrev_b32 v2, 6, v0
    v_and_b32 v1, 63, v0
    v_readfirstlane_b32 s30, v2
    s_sub_u32 s31, s2, 256
    v_lshrrev_b32 v7, 3, v1
    v_and_b32 v8, 7, v1
    s_mul_i32 s33, s30, 112
    v_add_u32 v2, s33, v7
    v_mul_u32_u24 v2, 3584, v2
    v_lshl_add_u32 v2, v8, 4, v2
    s_lshl_b32 s34, s31, 7
    v_add_u32 v6, s34, v2
    s_waitcnt lgkmcnt(0)
    s_mov_b32 s4, s20
    s_and_b32 s5, s21, 0xffff
    s_mov_b32 s6, 1605632
    s_mov_b32 s7, 0x20000
    s_mov_b32 s12, s24
    s_and_b32 s13, s25, 0xffff
    s_mov_b32 s14, 256
    s_mov_b32 s15, 0x20000
    s_mov_b32 s35, 0
    buffer_load_dwordx4 v[16:19], v6, s[4:7], s35 offen
    s_mov_b32 s35, 28672
    buffer_load_dwordx4 v[20:23], v6, s[4:7], s35 offen
    s_mov_b32 s35, 57344
    buffer_load_dwordx4 v[24:27], v6, s[4:7], s35 offen
    s_mov_b32 s35, 86016
    buffer_load_dwordx4 v[28:31], v6, s[4:7], s35 offen
    s_mov_b32 s35, 114688
    buffer_load_dwordx4 v[32:35], v6, s[4:7], s35 offen
    s_mov_b32 s35, 143360
    buffer_load_dwordx4 v[36:39], v6, s[4:7], s35 offen
    s_mov_b32 s35, 172032
    buffer_load_dwordx4 v[40:43], v6, s[4:7], s35 offen
    s_mov_b32 s35, 200704
    buffer_load_dwordx4 v[44:47], v6, s[4:7], s35 offen
    s_mov_b32 s35, 229376
    buffer_load_dwordx4 v[48:51], v6, s[4:7], s35 offen
    s_mov_b32 s35, 258048
    buffer_load_dwordx4 v[52:55], v6, s[4:7], s35 offen
    s_mov_b32 s35, 286720
    buffer_load_dwordx4 v[56:59], v6, s[4:7], s35 offen
    s_mov_b32 s35, 315392
    buffer_load_dwordx4 v[60:63], v6, s[4:7], s35 offen
    s_mov_b32 s35, 344064
    buffer_load_dwordx4 v[64:67], v6, s[4:7], s35 offen
    s_mov_b32 s35, 372736
    buffer_load_dwordx4 v[68:71], v6, s[4:7], s35 offen
    v_mov_b32 v12, 0
    buffer_load_dwordx2 v[10:11], v12, s[12:15], 0 offen sc1
    s_mov_b32 s8, s22
    s_and_b32 s9, s23, 0xffff
    s_mov_b32 s10, 13631488
    s_mov_b32 s11, 0x20000
    s_mov_b32 s38, 0x00003f80
    s_mov_b32 s39, 0x3f800000
    v_mov_b32 v72, 0
    v_mov_b32 v73, 0
    v_mov_b32 v74, 0
    v_mov_b32 v75, 0
    v_mov_b32 v76, 0
    v_mov_b32 v77, 0
    v_mov_b32 v78, 0
    v_mov_b32 v79, 0
    s_waitcnt vmcnt(14)
    v_dot2c_f32_bf16 v72, s38, v16
    v_dot2c_f32_bf16 v73, s39, v16
    v_dot2c_f32_bf16 v74, s38, v17
    v_dot2c_f32_bf16 v75, s39, v17
    v_dot2c_f32_bf16 v76, s38, v18
    v_dot2c_f32_bf16 v77, s39, v18
    v_dot2c_f32_bf16 v78, s38, v19
    v_dot2c_f32_bf16 v79, s39, v19
    s_waitcnt vmcnt(13)
    v_dot2c_f32_bf16 v72, s38, v20
    v_dot2c_f32_bf16 v73, s39, v20
    v_dot2c_f32_bf16 v74, s38, v21
    v_dot2c_f32_bf16 v75, s39, v21
    v_dot2c_f32_bf16 v76, s38, v22
    v_dot2c_f32_bf16 v77, s39, v22
    v_dot2c_f32_bf16 v78, s38, v23
    v_dot2c_f32_bf16 v79, s39, v23
    s_waitcnt vmcnt(12)
    v_dot2c_f32_bf16 v72, s38, v24
    v_dot2c_f32_bf16 v73, s39, v24
    v_dot2c_f32_bf16 v74, s38, v25
    v_dot2c_f32_bf16 v75, s39, v25
    v_dot2c_f32_bf16 v76, s38, v26
    v_dot2c_f32_bf16 v77, s39, v26
    v_dot2c_f32_bf16 v78, s38, v27
    v_dot2c_f32_bf16 v79, s39, v27
    s_waitcnt vmcnt(11)
    v_dot2c_f32_bf16 v72, s38, v28
    v_dot2c_f32_bf16 v73, s39, v28
    v_dot2c_f32_bf16 v74, s38, v29
    v_dot2c_f32_bf16 v75, s39, v29
    v_dot2c_f32_bf16 v76, s38, v30
    v_dot2c_f32_bf16 v77, s39, v30
    v_dot2c_f32_bf16 v78, s38, v31
    v_dot2c_f32_bf16 v79, s39, v31
    buffer_load_dwordx2 v[10:11], v12, s[12:15], 0 offen sc1
    s_waitcnt vmcnt(11)
    v_dot2c_f32_bf16 v72, s38, v32
    v_dot2c_f32_bf16 v73, s39, v32
    v_dot2c_f32_bf16 v74, s38, v33
    v_dot2c_f32_bf16 v75, s39, v33
    v_dot2c_f32_bf16 v76, s38, v34
    v_dot2c_f32_bf16 v77, s39, v34
    v_dot2c_f32_bf16 v78, s38, v35
    v_dot2c_f32_bf16 v79, s39, v35
    s_waitcnt vmcnt(10)
    v_dot2c_f32_bf16 v72, s38, v36
    v_dot2c_f32_bf16 v73, s39, v36
    v_dot2c_f32_bf16 v74, s38, v37
    v_dot2c_f32_bf16 v75, s39, v37
    v_dot2c_f32_bf16 v76, s38, v38
    v_dot2c_f32_bf16 v77, s39, v38
    v_dot2c_f32_bf16 v78, s38, v39
    v_dot2c_f32_bf16 v79, s39, v39
    s_waitcnt vmcnt(9)
    v_dot2c_f32_bf16 v72, s38, v40
    v_dot2c_f32_bf16 v73, s39, v40
    v_dot2c_f32_bf16 v74, s38, v41
    v_dot2c_f32_bf16 v75, s39, v41
    v_dot2c_f32_bf16 v76, s38, v42
    v_dot2c_f32_bf16 v77, s39, v42
    v_dot2c_f32_bf16 v78, s38, v43
    v_dot2c_f32_bf16 v79, s39, v43
    s_waitcnt vmcnt(8)
    v_dot2c_f32_bf16 v72, s38, v44
    v_dot2c_f32_bf16 v73, s39, v44
    v_dot2c_f32_bf16 v74, s38, v45
    v_dot2c_f32_bf16 v75, s39, v45
    v_dot2c_f32_bf16 v76, s38, v46
    v_dot2c_f32_bf16 v77, s39, v46
    v_dot2c_f32_bf16 v78, s38, v47
    v_dot2c_f32_bf16 v79, s39, v47
    s_waitcnt vmcnt(7)
    v_dot2c_f32_bf16 v72, s38, v48
    v_dot2c_f32_bf16 v73, s39, v48
    v_dot2c_f32_bf16 v74, s38, v49
    v_dot2c_f32_bf16 v75, s39, v49
    v_dot2c_f32_bf16 v76, s38, v50
    v_dot2c_f32_bf16 v77, s39, v50
    v_dot2c_f32_bf16 v78, s38, v51
    v_dot2c_f32_bf16 v79, s39, v51
    s_waitcnt vmcnt(6)
    v_dot2c_f32_bf16 v72, s38, v52
    v_dot2c_f32_bf16 v73, s39, v52
    v_dot2c_f32_bf16 v74, s38, v53
    v_dot2c_f32_bf16 v75, s39, v53
    v_dot2c_f32_bf16 v76, s38, v54
    v_dot2c_f32_bf16 v77, s39, v54
    v_dot2c_f32_bf16 v78, s38, v55
    v_dot2c_f32_bf16 v79, s39, v55
    s_waitcnt vmcnt(5)
    v_dot2c_f32_bf16 v72, s38, v56
    v_dot2c_f32_bf16 v73, s39, v56
    v_dot2c_f32_bf16 v74, s38, v57
    v_dot2c_f32_bf16 v75, s39, v57
    v_dot2c_f32_bf16 v76, s38, v58
    v_dot2c_f32_bf16 v77, s39, v58
    v_dot2c_f32_bf16 v78, s38, v59
    v_dot2c_f32_bf16 v79, s39, v59
    s_waitcnt vmcnt(4)
    v_dot2c_f32_bf16 v72, s38, v60
    v_dot2c_f32_bf16 v73, s39, v60
    v_dot2c_f32_bf16 v74, s38, v61
    v_dot2c_f32_bf16 v75, s39, v61
    v_dot2c_f32_bf16 v76, s38, v62
    v_dot2c_f32_bf16 v77, s39, v62
    v_dot2c_f32_bf16 v78, s38, v63
    v_dot2c_f32_bf16 v79, s39, v63
    s_waitcnt vmcnt(3)
    v_dot2c_f32_bf16 v72, s38, v64
    v_dot2c_f32_bf16 v73, s39, v64
    v_dot2c_f32_bf16 v74, s38, v65
    v_dot2c_f32_bf16 v75, s39, v65
    v_dot2c_f32_bf16 v76, s38, v66
    v_dot2c_f32_bf16 v77, s39, v66
    v_dot2c_f32_bf16 v78, s38, v67
    v_dot2c_f32_bf16 v79, s39, v67
    s_waitcnt vmcnt(2)
    v_dot2c_f32_bf16 v72, s38, v68
    v_dot2c_f32_bf16 v73, s39, v68
    v_dot2c_f32_bf16 v74, s38, v69
    v_dot2c_f32_bf16 v75, s39, v69
    v_dot2c_f32_bf16 v76, s38, v70
    v_dot2c_f32_bf16 v77, s39, v70
    v_dot2c_f32_bf16 v78, s38, v71
    v_dot2c_f32_bf16 v79, s39, v71
    s_lshl_b32 s33, s30, 3
    v_add_u32 v2, s33, v7
    v_lshlrev_b32 v2, 8, v2
    v_lshl_add_u32 v2, v8, 5, v2
    s_nop 1
    ds_write_b128 v2, v[72:75]
    ds_write_b128 v2, v[76:79] offset:16
    s_waitcnt lgkmcnt(0)
    s_barrier
    s_lshl_b32 s33, s30, 11
    v_lshlrev_b32 v2, 2, v1
    v_add_u32 v3, s33, v2
    ds_read_b32 v80, v3 offset:0
    ds_read_b32 v81, v3 offset:256
    ds_read_b32 v82, v3 offset:512
    ds_read_b32 v83, v3 offset:768
    ds_read_b32 v84, v3 offset:1024
    ds_read_b32 v85, v3 offset:1280
    ds_read_b32 v86, v3 offset:1536
    ds_read_b32 v87, v3 offset:1792
    s_waitcnt lgkmcnt(0)
    v_add_f32 v80, v80, v81
    v_add_f32 v82, v82, v83
    v_add_f32 v84, v84, v85
    v_add_f32 v86, v86, v87
    v_add_f32 v80, v80, v82
    v_add_f32 v84, v84, v86
    v_add_f32 v80, v80, v84
    s_lshl_b32 s33, s30, 8
    v_add_u32 v3, s33, v2
    ds_write_b32 v3, v80 offset:8192
    s_waitcnt vmcnt(0) lgkmcnt(0)
    s_barrier
    s_mov_b32 s34, 20000
NC_l_6:
    v_readfirstlane_b32 s28, v10
    v_readfirstlane_b32 s29, v11
    s_nop 1
    s_cmp_lg_u32 s28, 0
    s_cbranch_scc1 NC_ok_7
    s_sub_u32 s34, s34, 1
    s_cmp_eq_u32 s34, 0
    s_cbranch_scc1 NC_ok_7
    s_sleep 1
    buffer_load_dwordx2 v[10:11], v12, s[12:15], 0 offen sc1
    s_waitcnt vmcnt(0)
    s_branch NC_l_6
NC_ok_7:
    s_cmp_lg_u32 s30, 0
    s_cbranch_scc1 CS_w0_8
    v_and_b32 v2, 31, v1
    v_lshlrev_b32 v3, 3, v2
    ds_read_b64 v[80:81], v3 offset:8192
    ds_read_b64 v[82:83], v3 offset:8448
    ds_read_b64 v[84:85], v3 offset:8704
    ds_read_b64 v[86:87], v3 offset:8960
    s_waitcnt lgkmcnt(0)
    v_add_f32 v80, v80, v82
    v_add_f32 v84, v84, v86
    v_add_f32 v80, v80, v84
    v_add_f32 v81, v81, v83
    v_add_f32 v85, v85, v87
    v_add_f32 v81, v81, v85
    v_mov_b32 v82, s28
    v_mov_b32 v83, s29
    v_lshlrev_b32 v2, 4, v2
    s_lshl_b32 s33, s31, 9
    s_add_u32 s33, s33, 12754944
    buffer_store_dwordx4 v[80:83], v2, s[8:11], s33 offen sc1
CS_w0_8:
    s_waitcnt vmcnt(0)
    s_branch M_END
R_G:
    s_setprio 3
    s_load_dwordx2 s[4:5], s[0:1], 0
    s_load_dwordx2 s[8:9], s[0:1], 80
    v_lshrrev_b32 v2, 6, v0
    v_and_b32 v1, 63, v0
    v_readfirstlane_b32 s36, v2
    s_sub_u32 s41, s2, 288
    s_and_b32 s42, s41, 7
    s_lshr_b32 s43, s41, 3
    s_lshr_b32 s44, s42, 1
    s_lshl_b32 s44, s44, 2
    s_and_b32 s45, s43, 3
    s_add_u32 s39, s44, s45
    s_and_b32 s44, s42, 1
    s_mul_i32 s44, s44, 7
    s_lshr_b32 s45, s43, 2
    s_add_u32 s40, s44, s45
    v_lshrrev_b32 v2, 3, v1
    v_and_b32 v3, 7, v1
    v_lshrrev_b32 v4, 4, v1
    v_xor_b32 v3, v3, v4
    s_lshl_b32 s42, s36, 4
    s_lshl_b32 s43, s39, 7
    s_add_u32 s42, s42, s43
    v_add_u32 v2, s42, v2
    v_mul_u32_u24 v2, 896, v2
    v_lshl_add_u32 v6, v3, 4, v2
    v_xor_b32 v3, 4, v3
    v_lshl_add_u32 v7, v3, 4, v2
    v_add_u32 v7, 7168, v7
    s_lshl_b32 s48, s36, 11
    s_and_b32 s37, s36, 1
    s_lshr_b32 s38, s36, 1
    s_waitcnt lgkmcnt(0)
    s_and_b32 s5, s5, 0xffff
    s_mov_b32 s6, 1835008
    s_mov_b32 s7, 0x20000
    s_and_b32 s9, s9, 0xffff
    s_mov_b32 s10, 1605632
    s_mov_b32 s11, 0x20000
    s_add_u32 m0, s48, 0
    s_mov_b32 s49, 0
    buffer_load_dwordx4 v6, s[4:7], s49 offen  lds
    s_add_u32 m0, s48, 1024
    s_mov_b32 s49, 0
    buffer_load_dwordx4 v7, s[4:7], s49 offen  lds
    s_load_dwordx2 s[16:17], s[0:1], 88
    s_load_dwordx2 s[12:13], s[0:1], 128
    s_load_dwordx2 s[20:21], s[0:1], 120
    s_load_dwordx2 s[24:25], s[0:1], 104
    s_load_dwordx2 s[26:27], s[0:1], 112
    s_load_dwordx2 s[32:33], s[0:1], 96
    v_and_b32 v3, 15, v1
    v_lshlrev_b32 v5, 2, v4
    v_xor_b32 v3, v3, v5
    s_lshl_b32 s42, s36, 3
    v_add_u32 v4, s42, v4
    v_mul_u32_u24 v4, 3584, v4
    v_lshl_add_u32 v8, v3, 4, v4
    s_lshl_b32 s43, s40, 8
    v_add_u32 v8, s43, v8
    v_add_u32 v9, 14336, v8
    s_add_u32 m0, s48, 8192
    s_mov_b32 s49, 57344
    buffer_load_dwordx4 v6, s[4:7], s49 offen  lds
    s_add_u32 m0, s48, 9216
    s_mov_b32 s49, 57344
    buffer_load_dwordx4 v7, s[4:7], s49 offen  lds
    s_add_u32 m0, s48, 49152
    s_mov_b32 s49, 0
    buffer_load_dwordx4 v8, s[8:11], s49 offen  lds
    s_add_u32 m0, s48, 50176
    s_mov_b32 s49, 0
    buffer_load_dwordx4 v9, s[8:11], s49 offen  lds
    s_waitcnt lgkmcnt(0)
    s_and_b32 s21, s21, 0xffff
    s_mov_b32 s22, 256
    s_mov_b32 s23, 0x20000
    s_and_b32 s17, s17, 0xffff
    s_mov_b32 s18, 3584
    s_mov_b32 s19, 0x20000
    v_and_b32 v13, 31, v1
    v_lshlrev_b32 v13, 2, v13
    s_lshl_b32 s46, s40, 8
    s_lshl_b32 s47, s37, 7
    s_add_u32 s46, s46, s47
    buffer_load_dword v13, v13, s[16:19], s46 offen
    s_add_u32 m0, s48, 57344
    s_mov_b32 s49, 114688
    buffer_load_dwordx4 v8, s[8:11], s49 offen  lds
    v_lshrrev_b32 v2, 4, v1
    v_bfe_u32 v3, v1, 2, 2
    v_and_b32 v4, 3, v1
    v_and_b32 v5, 1, v2
    v_lshlrev_b32 v5, 1, v5
    v_lshrrev_b32 v14, 1, v4
    v_add_u32 v5, v5, v14
    s_lshl_b32 s42, s37, 3
    v_add_u32 v5, s42, v5
    v_lshlrev_b32 v14, 2, v3
    s_add_u32 m0, s48, 58368
    s_mov_b32 s49, 114688
    buffer_load_dwordx4 v9, s[8:11], s49 offen  lds
    v_xor_b32 v5, v5, v14
    v_lshlrev_b32 v5, 4, v5
    v_and_b32 v4, 1, v4
    v_lshl_add_u32 v5, v4, 3, v5
    v_lshrrev_b32 v2, 1, v2
    v_lshl_add_u32 v2, v2, 3, v3
    v_lshl_add_u32 v5, v2, 8, v5
    v_add_u32 v14, 49152, v5
    v_xor_b32 v15, 64, v14
    v_and_b32 v20, 31, v1
    s_add_u32 m0, s48, 16384
    s_mov_b32 s49, 128
    buffer_load_dwordx4 v6, s[4:7], s49 offen  lds
    s_lshl_b32 s42, s38, 6
    v_add_u32 v20, s42, v20
    v_bfe_u32 v2, v20, 1, 3
    v_lshrrev_b32 v3, 5, v1
    v_xor_b32 v2, v2, v3
    v_lshlrev_b32 v2, 4, v2
    v_lshl_add_u32 v16, v20, 7, v2
    v_xor_b32 v17, 32, v16
    v_xor_b32 v18, 64, v16
    v_xor_b32 v19, 96, v16
    s_add_u32 m0, s48, 17408
    s_mov_b32 s49, 128
    buffer_load_dwordx4 v7, s[4:7], s49 offen  lds
    v_mov_b32 v40, 0
    v_mov_b32 v41, 0
    v_mov_b32 v42, 0
    v_mov_b32 v43, 0
    v_mov_b32 v44, 0
    v_mov_b32 v45, 0
    v_mov_b32 v46, 0
    v_mov_b32 v47, 0
    v_mov_b32 v48, 0
    v_mov_b32 v49, 0
    s_add_u32 m0, s48, 24576
    s_mov_b32 s49, 57472
    buffer_load_dwordx4 v6, s[4:7], s49 offen  lds
    v_mov_b32 v50, 0
    v_mov_b32 v51, 0
    v_mov_b32 v52, 0
    v_mov_b32 v53, 0
    v_mov_b32 v54, 0
    v_mov_b32 v55, 0
    v_mov_b32 v56, 0
    v_mov_b32 v57, 0
    v_mov_b32 v58, 0
    v_mov_b32 v59, 0
    s_add_u32 m0, s48, 25600
    s_mov_b32 s49, 57472
    buffer_load_dwordx4 v7, s[4:7], s49 offen  lds
    v_mov_b32 v60, 0
    v_mov_b32 v61, 0
    v_mov_b32 v62, 0
    v_mov_b32 v63, 0
    v_mov_b32 v64, 0
    v_mov_b32 v65, 0
    v_mov_b32 v66, 0
    v_mov_b32 v67, 0
    v_mov_b32 v68, 0
    v_mov_b32 v69, 0
    s_add_u32 m0, s48, 65536
    s_mov_b32 s49, 229376
    buffer_load_dwordx4 v8, s[8:11], s49 offen  lds
    v_mov_b32 v70, 0
    v_mov_b32 v71, 0
    v_mov_b32 v72, 0
    v_mov_b32 v73, 0
    v_mov_b32 v74, 0
    v_mov_b32 v75, 0
    v_mov_b32 v76, 0
    v_mov_b32 v77, 0
    v_mov_b32 v78, 0
    v_mov_b32 v79, 0
    s_add_u32 m0, s48, 66560
    s_mov_b32 s49, 229376
    buffer_load_dwordx4 v9, s[8:11], s49 offen  lds
    v_mov_b32 v80, 0
    v_mov_b32 v81, 0
    v_mov_b32 v82, 0
    v_mov_b32 v83, 0
    v_mov_b32 v84, 0
    v_mov_b32 v85, 0
    v_mov_b32 v86, 0
    v_mov_b32 v87, 0
    v_mov_b32 v88, 0
    v_mov_b32 v89, 0
    v_mov_b32 v90, 0
    v_mov_b32 v91, 0
    v_mov_b32 v92, 0
    v_mov_b32 v93, 0
    v_mov_b32 v94, 0
    v_mov_b32 v95, 0
    v_mov_b32 v96, 0
    v_mov_b32 v97, 0
    v_mov_b32 v98, 0
    v_mov_b32 v99, 0
    v_mov_b32 v100, 0
    v_mov_b32 v101, 0
    v_mov_b32 v102, 0
    v_mov_b32 v103, 0
    s_and_b32 s13, s13, 0xffff
    s_mov_b32 s14, 13631488
    s_mov_b32 s15, 0x20000
    s_and_b32 s33, s33, 0xffff
    s_mov_b32 s34, 1605632
    s_mov_b32 s35, 0x20000
    s_waitcnt vmcnt(9)
    s_barrier
    ds_read_b64_tr_b16 v[104:105], v14 offset:0
    ds_read_b64_tr_b16 v[106:107], v14 offset:1024
    ds_read_b128 v[112:115], v16 offset:0
    ds_read_b64_tr_b16 v[108:109], v15 offset:0
    ds_read_b64_tr_b16 v[110:111], v15 offset:1024
    ds_read_b128 v[116:119], v16 offset:4096
    s_waitcnt lgkmcnt(3)
    v_mfma_f32_32x32x16_bf16 v[40:55], v[104:107], v[112:115], v[40:55]
    ds_read_b64_tr_b16 v[120:121], v14 offset:4096
    ds_read_b64_tr_b16 v[122:123], v14 offset:5120
    ds_read_b128 v[128:131], v17 offset:0
    s_waitcnt lgkmcnt(4)
    v_mfma_f32_32x32x16_bf16 v[56:71], v[108:111], v[112:115], v[56:71]
    ds_read_b64_tr_b16 v[124:125], v15 offset:4096
    ds_read_b64_tr_b16 v[126:127], v15 offset:5120
    ds_read_b128 v[132:135], v17 offset:4096
    s_waitcnt lgkmcnt(6)
    v_mfma_f32_32x32x16_bf16 v[72:87], v[104:107], v[116:119], v[72:87]
    s_add_u32 m0, s48, 73728
    s_mov_b32 s49, 344064
    buffer_load_dwordx4 v8, s[8:11], s49 offen  lds
    v_mfma_f32_32x32x16_bf16 v[88:103], v[108:111], v[116:119], v[88:103]
    s_add_u32 m0, s48, 74752
    s_mov_b32 s49, 344064
    buffer_load_dwordx4 v9, s[8:11], s49 offen  lds
    s_waitcnt lgkmcnt(0)
    s_waitcnt vmcnt(8)
    v_mfma_f32_32x32x16_bf16 v[40:55], v[120:123], v[128:131], v[40:55]
    s_barrier
    ds_read_b64_tr_b16 v[104:105], v14 offset:8192
    ds_read_b64_tr_b16 v[106:107], v14 offset:9216
    ds_read_b128 v[112:115], v18 offset:0
    v_mfma_f32_32x32x16_bf16 v[56:71], v[124:127], v[128:131], v[56:71]
    ds_read_b64_tr_b16 v[108:109], v15 offset:8192
    ds_read_b64_tr_b16 v[110:111], v15 offset:9216
    ds_read_b128 v[116:119], v18 offset:4096
    v_mfma_f32_32x32x16_bf16 v[72:87], v[120:123], v[132:135], v[72:87]
    s_add_u32 m0, s48, 32768
    s_mov_b32 s49, 256
    buffer_load_dwordx4 v6, s[4:7], s49 offen  lds
    v_mfma_f32_32x32x16_bf16 v[88:103], v[124:127], v[132:135], v[88:103]
    s_add_u32 m0, s48, 33792
    s_mov_b32 s49, 256
    buffer_load_dwordx4 v7, s[4:7], s49 offen  lds
    s_waitcnt lgkmcnt(3)
    v_mfma_f32_32x32x16_bf16 v[40:55], v[104:107], v[112:115], v[40:55]
    ds_read_b64_tr_b16 v[120:121], v14 offset:12288
    ds_read_b64_tr_b16 v[122:123], v14 offset:13312
    ds_read_b128 v[128:131], v19 offset:0
    s_waitcnt lgkmcnt(4)
    v_mfma_f32_32x32x16_bf16 v[56:71], v[108:111], v[112:115], v[56:71]
    ds_read_b64_tr_b16 v[124:125], v15 offset:12288
    ds_read_b64_tr_b16 v[126:127], v15 offset:13312
    ds_read_b128 v[132:135], v19 offset:4096
    s_waitcnt lgkmcnt(6)
    v_mfma_f32_32x32x16_bf16 v[72:87], v[104:107], v[116:119], v[72:87]
    s_add_u32 m0, s48, 49152
    s_mov_b32 s49, 458752
    buffer_load_dwordx4 v8, s[8:11], s49 offen  lds
    v_mfma_f32_32x32x16_bf16 v[88:103], v[108:111], v[116:119], v[88:103]
    s_add_u32 m0, s48, 50176
    s_mov_b32 s49, 458752
    buffer_load_dwordx4 v9, s[8:11], s49 offen  lds
    s_waitcnt lgkmcnt(0)
    s_waitcnt vmcnt(6)
    v_mfma_f32_32x32x16_bf16 v[40:55], v[120:123], v[128:131], v[40:55]
    s_barrier
    ds_read_b64_tr_b16 v[104:105], v14 offset:16384
    ds_read_b64_tr_b16 v[106:107], v14 offset:17408
    ds_read_b128 v[112:115], v16 offset:16384
    v_mfma_f32_32x32x16_bf16 v[56:71], v[124:127], v[128:131], v[56:71]
    ds_read_b64_tr_b16 v[108:109], v15 offset:16384
    ds_read_b64_tr_b16 v[110:111], v15 offset:17408
    ds_read_b128 v[116:119], v16 offset:20480
    v_mfma_f32_32x32x16_bf16 v[72:87], v[120:123], v[132:135], v[72:87]
    s_add_u32 m0, s48, 40960
    s_mov_b32 s49, 57600
    buffer_load_dwordx4 v6, s[4:7], s49 offen  lds
    v_mfma_f32_32x32x16_bf16 v[88:103], v[124:127], v[132:135], v[88:103]
    s_add_u32 m0, s48, 41984
    s_mov_b32 s49, 57600
    buffer_load_dwordx4 v7, s[4:7], s49 offen  lds
    s_waitcnt lgkmcnt(3)
    v_mfma_f32_32x32x16_bf16 v[40:55], v[104:107], v[112:115], v[40:55]
    ds_read_b64_tr_b16 v[120:121], v14 offset:20480
    ds_read_b64_tr_b16 v[122:123], v14 offset:21504
    ds_read_b128 v[128:131], v17 offset:16384
    s_waitcnt lgkmcnt(4)
    v_mfma_f32_32x32x16_bf16 v[56:71], v[108:111], v[112:115], v[56:71]
    ds_read_b64_tr_b16 v[124:125], v15 offset:20480
    ds_read_b64_tr_b16 v[126:127], v15 offset:21504
    ds_read_b128 v[132:135], v17 offset:20480
    s_waitcnt lgkmcnt(6)
    v_mfma_f32_32x32x16_bf16 v[72:87], v[104:107], v[116:119], v[72:87]
    s_add_u32 m0, s48, 57344
    s_mov_b32 s49, 573440
    buffer_load_dwordx4 v8, s[8:11], s49 offen  lds
    v_mfma_f32_32x32x16_bf16 v[88:103], v[108:111], v[116:119], v[88:103]
    s_add_u32 m0, s48, 58368
    s_mov_b32 s49, 573440
    buffer_load_dwordx4 v9, s[8:11], s49 offen  lds
    s_waitcnt lgkmcnt(0)
    s_waitcnt vmcnt(8)
    v_mfma_f32_32x32x16_bf16 v[40:55], v[120:123], v[128:131], v[40:55]
    s_barrier
    ds_read_b64_tr_b16 v[104:105], v14 offset:24576
    ds_read_b64_tr_b16 v[106:107], v14 offset:25600
    ds_read_b128 v[112:115], v18 offset:16384
    v_mfma_f32_32x32x16_bf16 v[56:71], v[124:127], v[128:131], v[56:71]
    ds_read_b64_tr_b16 v[108:109], v15 offset:24576
    ds_read_b64_tr_b16 v[110:111], v15 offset:25600
    ds_read_b128 v[116:119], v18 offset:20480
    v_mfma_f32_32x32x16_bf16 v[72:87], v[120:123], v[132:135], v[72:87]
    s_add_u32 m0, s48, 0
    s_mov_b32 s49, 384
    buffer_load_dwordx4 v6, s[4:7], s49 offen  lds
    v_mfma_f32_32x32x16_bf16 v[88:103], v[124:127], v[132:135], v[88:103]
    s_add_u32 m0, s48, 1024
    s_mov_b32 s49, 384
    buffer_load_dwordx4 v7, s[4:7], s49 offen  lds
    s_waitcnt lgkmcnt(3)
    v_mfma_f32_32x32x16_bf16 v[40:55], v[104:107], v[112:115], v[40:55]
    ds_read_b64_tr_b16 v[120:121], v14 offset:28672
    ds_read_b64_tr_b16 v[122:123], v14 offset:29696
    ds_read_b128 v[128:131], v19 offset:16384
    s_waitcnt lgkmcnt(4)
    v_mfma_f32_32x32x16_bf16 v[56:71], v[108:111], v[112:115], v[56:71]
    ds_read_b64_tr_b16 v[124:125], v15 offset:28672
    ds_read_b64_tr_b16 v[126:127], v15 offset:29696
    ds_read_b128 v[132:135], v19 offset:20480
    s_waitcnt lgkmcnt(6)
    v_mfma_f32_32x32x16_bf16 v[72:87], v[104:107], v[116:119], v[72:87]
    s_add_u32 m0, s48, 65536
    s_mov_b32 s49, 688128
    buffer_load_dwordx4 v8, s[8:11], s49 offen  lds
    v_mfma_f32_32x32x16_bf16 v[88:103], v[108:111], v[116:119], v[88:103]
    s_add_u32 m0, s48, 66560
    s_mov_b32 s49, 688128
    buffer_load_dwordx4 v9, s[8:11], s49 offen  lds
    s_waitcnt lgkmcnt(0)
    s_waitcnt vmcnt(6)
    v_mfma_f32_32x32x16_bf16 v[40:55], v[120:123], v[128:131], v[40:55]
    s_barrier
    ds_read_b64_tr_b16 v[104:105], v14 offset:0
    ds_read_b64_tr_b16 v[106:107], v14 offset:1024
    ds_read_b128 v[112:115], v16 offset:32768
    v_mfma_f32_32x32x16_bf16 v[56:71], v[124:127], v[128:131], v[56:71]
    ds_read_b64_tr_b16 v[108:109], v15 offset:0
    ds_read_b64_tr_b16 v[110:111], v15 offset:1024
    ds_read_b128 v[116:119], v16 offset:36864
    v_mfma_f32_32x32x16_bf16 v[72:87], v[120:123], v[132:135], v[72:87]
    s_add_u32 m0, s48, 8192
    s_mov_b32 s49, 57728
    buffer_load_dwordx4 v6, s[4:7], s49 offen  lds
    v_mfma_f32_32x32x16_bf16 v[88:103], v[124:127], v[132:135], v[88:103]
    s_add_u32 m0, s48, 9216
    s_mov_b32 s49, 57728
    buffer_load_dwordx4 v7, s[4:7], s49 offen  lds
    s_waitcnt lgkmcnt(3)
    v_mfma_f32_32x32x16_bf16 v[40:55], v[104:107], v[112:115], v[40:55]
    ds_read_b64_tr_b16 v[120:121], v14 offset:4096
    ds_read_b64_tr_b16 v[122:123], v14 offset:5120
    ds_read_b128 v[128:131], v17 offset:32768
    s_waitcnt lgkmcnt(4)
    v_mfma_f32_32x32x16_bf16 v[56:71], v[108:111], v[112:115], v[56:71]
    ds_read_b64_tr_b16 v[124:125], v15 offset:4096
    ds_read_b64_tr_b16 v[126:127], v15 offset:5120
    ds_read_b128 v[132:135], v17 offset:36864
    s_waitcnt lgkmcnt(6)
    v_mfma_f32_32x32x16_bf16 v[72:87], v[104:107], v[116:119], v[72:87]
    s_add_u32 m0, s48, 73728
    s_mov_b32 s49, 802816
    buffer_load_dwordx4 v8, s[8:11], s49 offen  lds
    v_mfma_f32_32x32x16_bf16 v[88:103], v[108:111], v[116:119], v[88:103]
    s_add_u32 m0, s48, 74752
    s_mov_b32 s49, 802816
    buffer_load_dwordx4 v9, s[8:11], s49 offen  lds
    s_waitcnt lgkmcnt(0)
    s_waitcnt vmcnt(8)
    v_mfma_f32_32x32x16_bf16 v[40:55], v[120:123], v[128:131], v[40:55]
    s_barrier
    ds_read_b64_tr_b16 v[104:105], v14 offset:8192
    ds_read_b64_tr_b16 v[106:107], v14 offset:9216
    ds_read_b128 v[112:115], v18 offset:32768
    v_mfma_f32_32x32x16_bf16 v[56:71], v[124:127], v[128:131], v[56:71]
    ds_read_b64_tr_b16 v[108:109], v15 offset:8192
    ds_read_b64_tr_b16 v[110:111], v15 offset:9216
    ds_read_b128 v[116:119], v18 offset:36864
    v_mfma_f32_32x32x16_bf16 v[72:87], v[120:123], v[132:135], v[72:87]
    s_add_u32 m0, s48, 16384
    s_mov_b32 s49, 512
    buffer_load_dwordx4 v6, s[4:7], s49 offen  lds
    v_mfma_f32_32x32x16_bf16 v[88:103], v[124:127], v[132:135], v[88:103]
    s_add_u32 m0, s48, 17408
    s_mov_b32 s49, 512
    buffer_load_dwordx4 v7, s[4:7], s49 offen  lds
    s_waitcnt lgkmcnt(3)
    v_mfma_f32_32x32x16_bf16 v[40:55], v[104:107], v[112:115], v[40:55]
    ds_read_b64_tr_b16 v[120:121], v14 offset:12288
    ds_read_b64_tr_b16 v[122:123], v14 offset:13312
    ds_read_b128 v[128:131], v19 offset:32768
    s_waitcnt lgkmcnt(4)
    v_mfma_f32_32x32x16_bf16 v[56:71], v[108:111], v[112:115], v[56:71]
    ds_read_b64_tr_b16 v[124:125], v15 offset:12288
    ds_read_b64_tr_b16 v[126:127], v15 offset:13312
    ds_read_b128 v[132:135], v19 offset:36864
    s_waitcnt lgkmcnt(6)
    v_mfma_f32_32x32x16_bf16 v[72:87], v[104:107], v[116:119], v[72:87]
    s_add_u32 m0, s48, 49152
    s_mov_b32 s49, 917504
    buffer_load_dwordx4 v8, s[8:11], s49 offen  lds
    v_mfma_f32_32x32x16_bf16 v[88:103], v[108:111], v[116:119], v[88:103]
    s_add_u32 m0, s48, 50176
    s_mov_b32 s49, 917504
    buffer_load_dwordx4 v9, s[8:11], s49 offen  lds
    s_waitcnt lgkmcnt(0)
    s_waitcnt vmcnt(6)
    v_mfma_f32_32x32x16_bf16 v[40:55], v[120:123], v[128:131], v[40:55]
    s_barrier
    ds_read_b64_tr_b16 v[104:105], v14 offset:16384
    ds_read_b64_tr_b16 v[106:107], v14 offset:17408
    ds_read_b128 v[112:115], v16 offset:0
    v_mfma_f32_32x32x16_bf16 v[56:71], v[124:127], v[128:131], v[56:71]
    ds_read_b64_tr_b16 v[108:109], v15 offset:16384
    ds_read_b64_tr_b16 v[110:111], v15 offset:17408
    ds_read_b128 v[116:119], v16 offset:4096
    v_mfma_f32_32x32x16_bf16 v[72:87], v[120:123], v[132:135], v[72:87]
    s_add_u32 m0, s48, 24576
    s_mov_b32 s49, 57856
    buffer_load_dwordx4 v6, s[4:7], s49 offen  lds
    v_mfma_f32_32x32x16_bf16 v[88:103], v[124:127], v[132:135], v[88:103]
    s_add_u32 m0, s48, 25600
    s_mov_b32 s49, 57856
    buffer_load_dwordx4 v7, s[4:7], s49 offen  lds
    s_waitcnt lgkmcnt(3)
    v_mfma_f32_32x32x16_bf16 v[40:55], v[104:107], v[112:115], v[40:55]
    ds_read_b64_tr_b16 v[120:121], v14 offset:20480
    ds_read_b64_tr_b16 v[122:123], v14 offset:21504
    ds_read_b128 v[128:131], v17 offset:0
    s_waitcnt lgkmcnt(4)
    v_mfma_f32_32x32x16_bf16 v[56:71], v[108:111], v[112:115], v[56:71]
    ds_read_b64_tr_b16 v[124:125], v15 offset:20480
    ds_read_b64_tr_b16 v[126:127], v15 offset:21504
    ds_read_b128 v[132:135], v17 offset:4096
    s_waitcnt lgkmcnt(6)
    v_mfma_f32_32x32x16_bf16 v[72:87], v[104:107], v[116:119], v[72:87]
    s_add_u32 m0, s48, 57344
    s_mov_b32 s49, 1032192
    buffer_load_dwordx4 v8, s[8:11], s49 offen  lds
    v_mfma_f32_32x32x16_bf16 v[88:103], v[108:111], v[116:119], v[88:103]
    s_add_u32 m0, s48, 58368
    s_mov_b32 s49, 1032192
    buffer_load_dwordx4 v9, s[8:11], s49 offen  lds
    s_waitcnt lgkmcnt(0)
    s_waitcnt vmcnt(8)
    v_mfma_f32_32x32x16_bf16 v[40:55], v[120:123], v[128:131], v[40:55]
    s_barrier
    ds_read_b64_tr_b16 v[104:105], v14 offset:24576
    ds_read_b64_tr_b16 v[106:107], v14 offset:25600
    ds_read_b128 v[112:115], v18 offset:0
    v_mfma_f32_32x32x16_bf16 v[56:71], v[124:127], v[128:131], v[56:71]
    ds_read_b64_tr_b16 v[108:109], v15 offset:24576
    ds_read_b64_tr_b16 v[110:111], v15 offset:25600
    ds_read_b128 v[116:119], v18 offset:4096
    v_mfma_f32_32x32x16_bf16 v[72:87], v[120:123], v[132:135], v[72:87]
    s_add_u32 m0, s48, 32768
    s_mov_b32 s49, 640
    buffer_load_dwordx4 v6, s[4:7], s49 offen  lds
    v_mfma_f32_32x32x16_bf16 v[88:103], v[124:127], v[132:135], v[88:103]
    s_add_u32 m0, s48, 33792
    s_mov_b32 s49, 640
    buffer_load_dwordx4 v7, s[4:7], s49 offen  lds
    s_waitcnt lgkmcnt(3)
    v_mfma_f32_32x32x16_bf16 v[40:55], v[104:107], v[112:115], v[40:55]
    ds_read_b64_tr_b16 v[120:121], v14 offset:28672
    ds_read_b64_tr_b16 v[122:123], v14 offset:29696
    ds_read_b128 v[128:131], v19 offset:0
    s_waitcnt lgkmcnt(4)
    v_mfma_f32_32x32x16_bf16 v[56:71], v[108:111], v[112:115], v[56:71]
    ds_read_b64_tr_b16 v[124:125], v15 offset:28672
    ds_read_b64_tr_b16 v[126:127], v15 offset:29696
    ds_read_b128 v[132:135], v19 offset:4096
    s_waitcnt lgkmcnt(6)
    v_mfma_f32_32x32x16_bf16 v[72:87], v[104:107], v[116:119], v[72:87]
    s_add_u32 m0, s48, 65536
    s_mov_b32 s49, 1146880
    buffer_load_dwordx4 v8, s[8:11], s49 offen  lds
    v_mfma_f32_32x32x16_bf16 v[88:103], v[108:111], v[116:119], v[88:103]
    s_add_u32 m0, s48, 66560
    s_mov_b32 s49, 1146880
    buffer_load_dwordx4 v9, s[8:11], s49 offen  lds
    s_waitcnt lgkmcnt(0)
    s_waitcnt vmcnt(6)
    v_mfma_f32_32x32x16_bf16 v[40:55], v[120:123], v[128:131], v[40:55]
    s_barrier
    ds_read_b64_tr_b16 v[104:105], v14 offset:0
    ds_read_b64_tr_b16 v[106:107], v14 offset:1024
    ds_read_b128 v[112:115], v16 offset:16384
    v_mfma_f32_32x32x16_bf16 v[56:71], v[124:127], v[128:131], v[56:71]
    ds_read_b64_tr_b16 v[108:109], v15 offset:0
    ds_read_b64_tr_b16 v[110:111], v15 offset:1024
    ds_read_b128 v[116:119], v16 offset:20480
    v_mfma_f32_32x32x16_bf16 v[72:87], v[120:123], v[132:135], v[72:87]
    s_add_u32 m0, s48, 40960
    s_mov_b32 s49, 57984
    buffer_load_dwordx4 v6, s[4:7], s49 offen  lds
    v_mfma_f32_32x32x16_bf16 v[88:103], v[124:127], v[132:135], v[88:103]
    s_add_u32 m0, s48, 41984
    s_mov_b32 s49, 57984
    buffer_load_dwordx4 v7, s[4:7], s49 offen  lds
    s_waitcnt lgkmcnt(3)
    v_mfma_f32_32x32x16_bf16 v[40:55], v[104:107], v[112:115], v[40:55]
    ds_read_b64_tr_b16 v[120:121], v14 offset:4096
    ds_read_b64_tr_b16 v[122:123], v14 offset:5120
    ds_read_b128 v[128:131], v17 offset:16384
    s_waitcnt lgkmcnt(4)
    v_mfma_f32_32x32x16_bf16 v[56:71], v[108:111], v[112:115], v[56:71]
    ds_read_b64_tr_b16 v[124:125], v15 offset:4096
    ds_read_b64_tr_b16 v[126:127], v15 offset:5120
    ds_read_b128 v[132:135], v17 offset:20480
    s_waitcnt lgkmcnt(6)
    v_mfma_f32_32x32x16_bf16 v[72:87], v[104:107], v[116:119], v[72:87]
    s_add_u32 m0, s48, 73728
    s_mov_b32 s49, 1261568
    buffer_load_dwordx4 v8, s[8:11], s49 offen  lds
    v_mfma_f32_32x32x16_bf16 v[88:103], v[108:111], v[116:119], v[88:103]
    s_add_u32 m0, s48, 74752
    s_mov_b32 s49, 1261568
    buffer_load_dwordx4 v9, s[8:11], s49 offen  lds
    s_waitcnt lgkmcnt(0)
    s_waitcnt vmcnt(8)
    v_mfma_f32_32x32x16_bf16 v[40:55], v[120:123], v[128:131], v[40:55]
    s_barrier
    ds_read_b64_tr_b16 v[104:105], v14 offset:8192
    ds_read_b64_tr_b16 v[106:107], v14 offset:9216
    ds_read_b128 v[112:115], v18 offset:16384
    v_mfma_f32_32x32x16_bf16 v[56:71], v[124:127], v[128:131], v[56:71]
    ds_read_b64_tr_b16 v[108:109], v15 offset:8192
    ds_read_b64_tr_b16 v[110:111], v15 offset:9216
    ds_read_b128 v[116:119], v18 offset:20480
    v_mfma_f32_32x32x16_bf16 v[72:87], v[120:123], v[132:135], v[72:87]
    s_add_u32 m0, s48, 0
    s_mov_b32 s49, 768
    buffer_load_dwordx4 v6, s[4:7], s49 offen  lds
    v_mfma_f32_32x32x16_bf16 v[88:103], v[124:127], v[132:135], v[88:103]
    s_add_u32 m0, s48, 1024
    s_mov_b32 s49, 768
    buffer_load_dwordx4 v7, s[4:7], s49 offen  lds
    s_waitcnt lgkmcnt(3)
    v_mfma_f32_32x32x16_bf16 v[40:55], v[104:107], v[112:115], v[40:55]
    ds_read_b64_tr_b16 v[120:121], v14 offset:12288
    ds_read_b64_tr_b16 v[122:123], v14 offset:13312
    ds_read_b128 v[128:131], v19 offset:16384
    s_waitcnt lgkmcnt(4)
    v_mfma_f32_32x32x16_bf16 v[56:71], v[108:111], v[112:115], v[56:71]
    ds_read_b64_tr_b16 v[124:125], v15 offset:12288
    ds_read_b64_tr_b16 v[126:127], v15 offset:13312
    ds_read_b128 v[132:135], v19 offset:20480
    s_waitcnt lgkmcnt(6)
    v_mfma_f32_32x32x16_bf16 v[72:87], v[104:107], v[116:119], v[72:87]
    s_add_u32 m0, s48, 49152
    s_mov_b32 s49, 1376256
    buffer_load_dwordx4 v8, s[8:11], s49 offen  lds
    v_mfma_f32_32x32x16_bf16 v[88:103], v[108:111], v[116:119], v[88:103]
    s_add_u32 m0, s48, 50176
    s_mov_b32 s49, 1376256
    buffer_load_dwordx4 v9, s[8:11], s49 offen  lds
    s_waitcnt lgkmcnt(0)
    s_waitcnt vmcnt(6)
    v_mfma_f32_32x32x16_bf16 v[40:55], v[120:123], v[128:131], v[40:55]
    s_barrier
    ds_read_b64_tr_b16 v[104:105], v14 offset:16384
    ds_read_b64_tr_b16 v[106:107], v14 offset:17408
    ds_read_b128 v[112:115], v16 offset:32768
    v_mfma_f32_32x32x16_bf16 v[56:71], v[124:127], v[128:131], v[56:71]
    ds_read_b64_tr_b16 v[108:109], v15 offset:16384
    ds_read_b64_tr_b16 v[110:111], v15 offset:17408
    ds_read_b128 v[116:119], v16 offset:36864
    v_mfma_f32_32x32x16_bf16 v[72:87], v[120:123], v[132:135], v[72:87]
    s_add_u32 m0, s48, 8192
    s_mov_b32 s49, 58112
    buffer_load_dwordx4 v6, s[4:7], s49 offen  lds
    v_mfma_f32_32x32x16_bf16 v[88:103], v[124:127], v[132:135], v[88:103]
    s_add_u32 m0, s48, 9216
    s_mov_b32 s49, 58112
    buffer_load_dwordx4 v7, s[4:7], s49 offen  lds
    s_waitcnt lgkmcnt(3)
    v_mfma_f32_32x32x16_bf16 v[40:55], v[104:107], v[112:115], v[40:55]
    ds_read_b64_tr_b16 v[120:121], v14 offset:20480
    ds_read_b64_tr_b16 v[122:123], v14 offset:21504
    ds_read_b128 v[128:131], v17 offset:32768
    s_waitcnt lgkmcnt(4)
    v_mfma_f32_32x32x16_bf16 v[56:71], v[108:111], v[112:115], v[56:71]
    ds_read_b64_tr_b16 v[124:125], v15 offset:20480
    ds_read_b64_tr_b16 v[126:127], v15 offset:21504
    ds_read_b128 v[132:135], v17 offset:36864
    s_waitcnt lgkmcnt(6)
    v_mfma_f32_32x32x16_bf16 v[72:87], v[104:107], v[116:119], v[72:87]
    s_add_u32 m0, s48, 57344
    s_mov_b32 s49, 1490944
    buffer_load_dwordx4 v8, s[8:11], s49 offen  lds
    v_mfma_f32_32x32x16_bf16 v[88:103], v[108:111], v[116:119], v[88:103]
    v_mov_b32 v12, 0
    buffer_load_dwordx2 v[10:11], v12, s[20:23], 0 offen sc1
    s_lshl_b32 s42, s39, 7
    v_add_u32 v148, s42, v20
    v_lshlrev_b32 v148, 4, v148
    v_add_u32 v148, 12722176, v148
    v_and_b32 v149, 31, v1
    s_lshl_b32 s42, s40, 6
    s_lshl_b32 s43, s37, 5
    s_add_u32 s42, s42, s43
    v_add_u32 v149, s42, v149
    v_lshlrev_b32 v149, 4, v149
    v_add_u32 v149, 12754944, v149
    buffer_load_dwordx4 v[136:139], v148, s[12:15], 0 offen offset:0 sc1
    buffer_load_dwordx4 v[140:143], v148, s[12:15], 0 offen offset:512 sc1
    buffer_load_dwordx4 v[144:147], v149, s[12:15], 0 offen sc1
    s_and_b32 s42, s41, 7
    s_lshl_b32 s42, s42, 2
    s_bfe_u32 s43, s41, 0x20003
    s_add_u32 s57, s42, s43
    s_lshr_b32 s58, s41, 5
    s_lshr_b32 s59, s36, 1
    s_and_b32 s60, s36, 1
    s_lshl_b32 s61, s58, 6
    s_lshl_b32 s42, s59, 5
    s_add_u32 s61, s61, s42
    s_lshl_b32 s62, s57, 6
    s_lshl_b32 s42, s60, 5
    s_add_u32 s62, s62, s42
    s_add_u32 m0, s48, 58368
    s_mov_b32 s49, 1490944
    buffer_load_dwordx4 v9, s[8:11], s49 offen  lds
    s_waitcnt lgkmcnt(0)
    s_waitcnt vmcnt(12)
    v_mfma_f32_32x32x16_bf16 v[40:55], v[120:123], v[128:131], v[40:55]
    s_barrier
    ds_read_b64_tr_b16 v[104:105], v14 offset:24576
    ds_read_b64_tr_b16 v[106:107], v14 offset:25600
    ds_read_b128 v[112:115], v18 offset:32768
    v_mfma_f32_32x32x16_bf16 v[56:71], v[124:127], v[128:131], v[56:71]
    ds_read_b64_tr_b16 v[108:109], v15 offset:24576
    ds_read_b64_tr_b16 v[110:111], v15 offset:25600
    ds_read_b128 v[116:119], v18 offset:36864
    v_mfma_f32_32x32x16_bf16 v[72:87], v[120:123], v[132:135], v[72:87]
    v_mfma_f32_32x32x16_bf16 v[88:103], v[124:127], v[132:135], v[88:103]
    s_waitcnt lgkmcnt(3)
    v_mfma_f32_32x32x16_bf16 v[40:55], v[104:107], v[112:115], v[40:55]
    ds_read_b64_tr_b16 v[120:121], v14 offset:28672
    ds_read_b64_tr_b16 v[122:123], v14 offset:29696
    ds_read_b128 v[128:131], v19 offset:32768
    s_waitcnt lgkmcnt(4)
    v_mfma_f32_32x32x16_bf16 v[56:71], v[108:111], v[112:115], v[56:71]
    ds_read_b64_tr_b16 v[124:125], v15 offset:28672
    ds_read_b64_tr_b16 v[126:127], v15 offset:29696
    ds_read_b128 v[132:135], v19 offset:36864
    s_waitcnt lgkmcnt(6)
    v_mfma_f32_32x32x16_bf16 v[72:87], v[104:107], v[116:119], v[72:87]
    v_mfma_f32_32x32x16_bf16 v[88:103], v[108:111], v[116:119], v[88:103]
    s_waitcnt lgkmcnt(0)
    s_waitcnt vmcnt(6)
    v_mfma_f32_32x32x16_bf16 v[40:55], v[120:123], v[128:131], v[40:55]
    s_barrier
    ds_read_b64_tr_b16 v[104:105], v14 offset:0
    ds_read_b64_tr_b16 v[106:107], v14 offset:1024
    ds_read_b128 v[112:115], v16 offset:0
    v_mfma_f32_32x32x16_bf16 v[56:71], v[124:127], v[128:131], v[56:71]
    ds_read_b64_tr_b16 v[108:109], v15 offset:0
    ds_read_b64_tr_b16 v[110:111], v15 offset:1024
    ds_read_b128 v[116:119], v16 offset:4096
    v_mfma_f32_32x32x16_bf16 v[72:87], v[120:123], v[132:135], v[72:87]
    v_mfma_f32_32x32x16_bf16 v[88:103], v[124:127], v[132:135], v[88:103]
    s_waitcnt lgkmcnt(3)
    v_mfma_f32_32x32x16_bf16 v[40:55], v[104:107], v[112:115], v[40:55]
    ds_read_b64_tr_b16 v[120:121], v14 offset:4096
    ds_read_b64_tr_b16 v[122:123], v14 offset:5120
    ds_read_b128 v[128:131], v17 offset:0
    s_waitcnt lgkmcnt(4)
    v_mfma_f32_32x32x16_bf16 v[56:71], v[108:111], v[112:115], v[56:71]
    ds_read_b64_tr_b16 v[124:125], v15 offset:4096
    ds_read_b64_tr_b16 v[126:127], v15 offset:5120
    ds_read_b128 v[132:135], v17 offset:4096
    s_waitcnt lgkmcnt(6)
    v_mfma_f32_32x32x16_bf16 v[72:87], v[104:107], v[116:119], v[72:87]
    v_mfma_f32_32x32x16_bf16 v[88:103], v[108:111], v[116:119], v[88:103]
    s_mov_b32 s16, s24
    s_and_b32 s17, s25, 0xffff
    s_mov_b32 s18, 896
    s_mov_b32 s19, 0x20000
    v_and_b32 v2, 31, v1
    v_lshrrev_b32 v3, 5, v1
    v_add_u32 v4, s62, v2
    v_mul_u32_u24 v4, 896, v4
    v_lshl_add_u32 v4, v3, 3, v4
    s_lshl_b32 s42, s61, 1
    v_add_u32 v38, s42, v4
    buffer_load_dwordx2 v[22:23], v38, s[4:7], 0 offen offset:0
    buffer_load_dwordx2 v[24:25], v38, s[4:7], 0 offen offset:16
    buffer_load_dwordx2 v[26:27], v38, s[4:7], 0 offen offset:32
    buffer_load_dwordx2 v[28:29], v38, s[4:7], 0 offen offset:48
    v_lshlrev_b32 v4, 3, v3
    v_add_u32 v4, s42, v4
    buffer_load_dwordx2 v[30:31], v4, s[16:19], 0 offen offset:0
    buffer_load_dwordx2 v[32:33], v4, s[16:19], 0 offen offset:16
    buffer_load_dwordx2 v[34:35], v4, s[16:19], 0 offen offset:32
    buffer_load_dwordx2 v[36:37], v4, s[16:19], 0 offen offset:48
    s_waitcnt lgkmcnt(0)
    s_waitcnt vmcnt(8)
    v_mfma_f32_32x32x16_bf16 v[40:55], v[120:123], v[128:131], v[40:55]
    s_barrier
    ds_read_b64_tr_b16 v[104:105], v14 offset:8192
    ds_read_b64_tr_b16 v[106:107], v14 offset:9216
    ds_read_b128 v[112:115], v18 offset:0
    v_mfma_f32_32x32x16_bf16 v[56:71], v[124:127], v[128:131], v[56:71]
    ds_read_b64_tr_b16 v[108:109], v15 offset:8192
    ds_read_b64_tr_b16 v[110:111], v15 offset:9216
    ds_read_b128 v[116:119], v18 offset:4096
    v_mfma_f32_32x32x16_bf16 v[72:87], v[120:123], v[132:135], v[72:87]
    v_mfma_f32_32x32x16_bf16 v[88:103], v[124:127], v[132:135], v[88:103]
    s_waitcnt lgkmcnt(3)
    v_mfma_f32_32x32x16_bf16 v[40:55], v[104:107], v[112:115], v[40:55]
    ds_read_b64_tr_b16 v[120:121], v14 offset:12288
    ds_read_b64_tr_b16 v[122:123], v14 offset:13312
    ds_read_b128 v[128:131], v19 offset:0
    s_waitcnt lgkmcnt(4)
    v_mfma_f32_32x32x16_bf16 v[56:71], v[108:111], v[112:115], v[56:71]
    ds_read_b64_tr_b16 v[124:125], v15 offset:12288
    ds_read_b64_tr_b16 v[126:127], v15 offset:13312
    ds_read_b128 v[132:135], v19 offset:4096
    s_waitcnt lgkmcnt(6)
    v_mfma_f32_32x32x16_bf16 v[72:87], v[104:107], v[116:119], v[72:87]
    v_mfma_f32_32x32x16_bf16 v[88:103], v[108:111], v[116:119], v[88:103]
    s_waitcnt lgkmcnt(0)
    v_mfma_f32_32x32x16_bf16 v[40:55], v[120:123], v[128:131], v[40:55]
    v_mfma_f32_32x32x16_bf16 v[56:71], v[124:127], v[128:131], v[56:71]
    v_mfma_f32_32x32x16_bf16 v[72:87], v[120:123], v[132:135], v[72:87]
    v_mfma_f32_32x32x16_bf16 v[88:103], v[124:127], v[132:135], v[88:103]
    s_waitcnt vmcnt(9)
    s_mov_b32 s44, 20000
NC_l_9:
    v_readfirstlane_b32 s28, v10
    v_readfirstlane_b32 s29, v11
    s_nop 1
    s_cmp_lg_u32 s28, 0
    s_cbranch_scc1 NC_ok_10
    s_sub_u32 s44, s44, 1
    s_cmp_eq_u32 s44, 0
    s_cbranch_scc1 NC_ok_10
    s_sleep 1
    buffer_load_dwordx2 v[10:11], v12, s[20:23], 0 offen sc1
    s_waitcnt vmcnt(0)
    s_branch NC_l_9
NC_ok_10:
    s_mov_b32 s44, 20000
TG_l_11:
    v_cmp_ne_u32 vcc, s28, v138
    s_mov_b64 s[98:99], vcc
    v_cmp_ne_u32 vcc, s29, v139
    s_or_b64 s[98:99], s[98:99], vcc
    v_cmp_ne_u32 vcc, s28, v142
    s_or_b64 s[98:99], s[98:99], vcc
    v_cmp_ne_u32 vcc, s29, v143
    s_or_b64 s[98:99], s[98:99], vcc
    v_cmp_ne_u32 vcc, s28, v146
    s_or_b64 s[98:99], s[98:99], vcc
    v_cmp_ne_u32 vcc, s29, v147
    s_or_b64 s[98:99], s[98:99], vcc
    s_cmp_eq_u64 s[98:99], 0
    s_cbranch_scc1 TG_ok_12
    s_sub_u32 s44, s44, 1
    s_cmp_eq_u32 s44, 0
    s_cbranch_scc1 TG_ok_12
    s_sleep 1
    buffer_load_dwordx4 v[136:139], v148, s[12:15], 0 offen offset:0 sc1
    buffer_load_dwordx4 v[140:143], v148, s[12:15], 0 offen offset:512 sc1
    buffer_load_dwordx4 v[144:147], v149, s[12:15], 0 offen sc1
    s_waitcnt vmcnt(0)
    s_branch TG_l_11
TG_ok_12:
    v_and_b32 v2, 31, v1
    v_lshlrev_b32 v2, 3, v2
    s_lshl_b32 s42, s36, 10
    s_add_u32 s42, s42, 16384
    v_add_u32 v2, s42, v2
    ds_write_b64 v2, v[144:145]
    v_lshlrev_b32 v4, 16, v13
    v_and_b32 v5, 0xffff0000, v13
    ds_write_b64 v2, v[4:5] offset:256
    v_lshrrev_b32 v2, 5, v1
    v_lshlrev_b32 v2, 4, v2
    v_add_u32 v2, s42, v2
    ds_read_b128 v[156:159], v2 offset:0
    ds_read_b128 v[188:191], v2 offset:256
    ds_read_b128 v[160:163], v2 offset:32
    ds_read_b128 v[192:195], v2 offset:288
    ds_read_b128 v[164:167], v2 offset:64
    ds_read_b128 v[196:199], v2 offset:320
    ds_read_b128 v[168:171], v2 offset:96
    ds_read_b128 v[200:203], v2 offset:352
    ds_read_b128 v[172:175], v2 offset:128
    ds_read_b128 v[204:207], v2 offset:384
    ds_read_b128 v[176:179], v2 offset:160
    ds_read_b128 v[208:211], v2 offset:416
    ds_read_b128 v[180:183], v2 offset:192
    ds_read_b128 v[212:215], v2 offset:448
    ds_read_b128 v[184:187], v2 offset:224
    ds_read_b128 v[216:219], v2 offset:480
    s_lshl_b32 s42, s39, 2
    s_lshl_b32 s43, s38, 1
    s_add_u32 s42, s42, s43
    s_mul_i32 s42, s42, 113
    s_lshl_b32 s43, s40, 3
    s_add_u32 s42, s42, s43
    s_lshl_b32 s43, s37, 2
    s_add_u32 s42, s42, s43
    s_lshl_b32 s64, s42, 10
    v_lshlrev_b32 v220, 4, v1
    v_mov_b32 v222, 0xc0135761
    v_mov_b32 v223, 0xbdd2d3e8
    v_mov_b32 v224, 1.0
    v_mov_b32 v226, v136
    v_mov_b32 v227, v137
    s_mov_b32 s65, 0
    s_mov_b32 s66, 0
    s_mov_b32 s67, 0
    s_waitcnt lgkmcnt(0)
G1_ge_13:
    s_set_gpr_idx_on s67, gpr_idx(SRC1,SRC2)
    v_pk_fma_f32 v[104:105], v[226:227], v[156:157], v[188:189] op_sel:[0,0,0] op_sel_hi:[0,1,1] neg_lo:[1,0,0] neg_hi:[1,0,0]
    v_pk_fma_f32 v[106:107], v[226:227], v[158:159], v[190:191] op_sel:[0,0,0] op_sel_hi:[0,1,1] neg_lo:[1,0,0] neg_hi:[1,0,0]
    v_pk_fma_f32 v[108:109], v[226:227], v[160:161], v[192:193] op_sel:[0,0,0] op_sel_hi:[0,1,1] neg_lo:[1,0,0] neg_hi:[1,0,0]
    v_pk_fma_f32 v[110:111], v[226:227], v[162:163], v[194:195] op_sel:[0,0,0] op_sel_hi:[0,1,1] neg_lo:[1,0,0] neg_hi:[1,0,0]
    s_set_gpr_idx_on s66, gpr_idx(SRC0)
    v_pk_fma_f32 v[104:105], v[40:41], v[226:227], v[104:105] op_sel:[0,1,0] op_sel_hi:[1,1,1]
    v_pk_fma_f32 v[106:107], v[42:43], v[226:227], v[106:107] op_sel:[0,1,0] op_sel_hi:[1,1,1]
    v_pk_fma_f32 v[108:109], v[44:45], v[226:227], v[108:109] op_sel:[0,1,0] op_sel_hi:[1,1,1]
    v_pk_fma_f32 v[110:111], v[46:47], v[226:227], v[110:111] op_sel:[0,1,0] op_sel_hi:[1,1,1]
    s_set_gpr_idx_off
    v_pk_mul_f32 v[112:113], v[104:105], v[104:105]
    v_pk_mul_f32 v[114:115], v[106:107], v[106:107]
    v_pk_mul_f32 v[116:117], v[108:109], v[108:109]
    v_pk_mul_f32 v[118:119], v[110:111], v[110:111]
    v_pk_fma_f32 v[112:113], v[112:113], v[222:223], v[222:223] op_sel:[0,1,0] op_sel_hi:[1,1,0]
    v_pk_fma_f32 v[114:115], v[114:115], v[222:223], v[222:223] op_sel:[0,1,0] op_sel_hi:[1,1,0]
    v_pk_fma_f32 v[116:117], v[116:117], v[222:223], v[222:223] op_sel:[0,1,0] op_sel_hi:[1,1,0]
    v_pk_fma_f32 v[118:119], v[118:119], v[222:223], v[222:223] op_sel:[0,1,0] op_sel_hi:[1,1,0]
    v_pk_mul_f32 v[112:113], v[112:113], v[104:105]
    v_pk_mul_f32 v[114:115], v[114:115], v[106:107]
    v_pk_mul_f32 v[116:117], v[116:117], v[108:109]
    v_pk_mul_f32 v[118:119], v[118:119], v[110:111]
    v_exp_f32 v112, v112
    v_exp_f32 v113, v113
    v_exp_f32 v114, v114
    v_exp_f32 v115, v115
    v_exp_f32 v116, v116
    v_exp_f32 v117, v117
    v_exp_f32 v118, v118
    v_exp_f32 v119, v119
    v_pk_add_f32 v[112:113], v[112:113], v[224:225] op_sel:[0,0] op_sel_hi:[1,0]
    v_pk_add_f32 v[114:115], v[114:115], v[224:225] op_sel:[0,0] op_sel_hi:[1,0]
    v_pk_add_f32 v[116:117], v[116:117], v[224:225] op_sel:[0,0] op_sel_hi:[1,0]
    v_pk_add_f32 v[118:119], v[118:119], v[224:225] op_sel:[0,0] op_sel_hi:[1,0]
    v_rcp_f32 v112, v112
    v_rcp_f32 v113, v113
    v_rcp_f32 v114, v114
    v_rcp_f32 v115, v115
    v_rcp_f32 v116, v116
    v_rcp_f32 v117, v117
    v_rcp_f32 v118, v118
    v_rcp_f32 v119, v119
    v_pk_mul_f32 v[104:105], v[104:105], v[112:113]
    v_pk_mul_f32 v[106:107], v[106:107], v[114:115]
    v_pk_mul_f32 v[108:109], v[108:109], v[116:117]
    v_pk_mul_f32 v[110:111], v[110:111], v[118:119]
    v_cvt_pk_bf16_f32 v120, v104, v105
    v_cvt_pk_bf16_f32 v121, v106, v107
    v_cvt_pk_bf16_f32 v122, v108, v109
    v_cvt_pk_bf16_f32 v123, v110, v111
    buffer_store_dwordx4 v[120:123], v220, s[12:15], s64 offen sc1
    s_add_u32 s64, s64, 1024
    s_add_u32 s66, s66, 8
    s_add_u32 s67, s67, 8
    s_set_gpr_idx_on s67, gpr_idx(SRC1,SRC2)
    v_pk_fma_f32 v[104:105], v[226:227], v[156:157], v[188:189] op_sel:[0,0,0] op_sel_hi:[0,1,1] neg_lo:[1,0,0] neg_hi:[1,0,0]
    v_pk_fma_f32 v[106:107], v[226:227], v[158:159], v[190:191] op_sel:[0,0,0] op_sel_hi:[0,1,1] neg_lo:[1,0,0] neg_hi:[1,0,0]
    v_pk_fma_f32 v[108:109], v[226:227], v[160:161], v[192:193] op_sel:[0,0,0] op_sel_hi:[0,1,1] neg_lo:[1,0,0] neg_hi:[1,0,0]
    v_pk_fma_f32 v[110:111], v[226:227], v[162:163], v[194:195] op_sel:[0,0,0] op_sel_hi:[0,1,1] neg_lo:[1,0,0] neg_hi:[1,0,0]
    s_set_gpr_idx_on s66, gpr_idx(SRC0)
    v_pk_fma_f32 v[104:105], v[40:41], v[226:227], v[104:105] op_sel:[0,1,0] op_sel_hi:[1,1,1]
    v_pk_fma_f32 v[106:107], v[42:43], v[226:227], v[106:107] op_sel:[0,1,0] op_sel_hi:[1,1,1]
    v_pk_fma_f32 v[108:109], v[44:45], v[226:227], v[108:109] op_sel:[0,1,0] op_sel_hi:[1,1,1]
    v_pk_fma_f32 v[110:111], v[46:47], v[226:227], v[110:111] op_sel:[0,1,0] op_sel_hi:[1,1,1]
    s_set_gpr_idx_off
    v_pk_mul_f32 v[112:113], v[104:105], v[104:105]
    v_pk_mul_f32 v[114:115], v[106:107], v[106:107]
    v_pk_mul_f32 v[116:117], v[108:109], v[108:109]
    v_pk_mul_f32 v[118:119], v[110:111], v[110:111]
    v_pk_fma_f32 v[112:113], v[112:113], v[222:223], v[222:223] op_sel:[0,1,0] op_sel_hi:[1,1,0]
    v_pk_fma_f32 v[114:115], v[114:115], v[222:223], v[222:223] op_sel:[0,1,0] op_sel_hi:[1,1,0]
    v_pk_fma_f32 v[116:117], v[116:117], v[222:223], v[222:223] op_sel:[0,1,0] op_sel_hi:[1,1,0]
    v_pk_fma_f32 v[118:119], v[118:119], v[222:223], v[222:223] op_sel:[0,1,0] op_sel_hi:[1,1,0]
    v_pk_mul_f32 v[112:113], v[112:113], v[104:105]
    v_pk_mul_f32 v[114:115], v[114:115], v[106:107]
    v_pk_mul_f32 v[116:117], v[116:117], v[108:109]
    v_pk_mul_f32 v[118:119], v[118:119], v[110:111]
    v_exp_f32 v112, v112
    v_exp_f32 v113, v113
    v_exp_f32 v114, v114
    v_exp_f32 v115, v115
    v_exp_f32 v116, v116
    v_exp_f32 v117, v117
    v_exp_f32 v118, v118
    v_exp_f32 v119, v119
    v_pk_add_f32 v[112:113], v[112:113], v[224:225] op_sel:[0,0] op_sel_hi:[1,0]
    v_pk_add_f32 v[114:115], v[114:115], v[224:225] op_sel:[0,0] op_sel_hi:[1,0]
    v_pk_add_f32 v[116:117], v[116:117], v[224:225] op_sel:[0,0] op_sel_hi:[1,0]
    v_pk_add_f32 v[118:119], v[118:119], v[224:225] op_sel:[0,0] op_sel_hi:[1,0]
    v_rcp_f32 v112, v112
    v_rcp_f32 v113, v113
    v_rcp_f32 v114, v114
    v_rcp_f32 v115, v115
    v_rcp_f32 v116, v116
    v_rcp_f32 v117, v117
    v_rcp_f32 v118, v118
    v_rcp_f32 v119, v119
    v_pk_mul_f32 v[104:105], v[104:105], v[112:113]
    v_pk_mul_f32 v[106:107], v[106:107], v[114:115]
    v_pk_mul_f32 v[108:109], v[108:109], v[116:117]
    v_pk_mul_f32 v[110:111], v[110:111], v[118:119]
    v_cvt_pk_bf16_f32 v124, v104, v105
    v_cvt_pk_bf16_f32 v125, v106, v107
    v_cvt_pk_bf16_f32 v126, v108, v109
    v_cvt_pk_bf16_f32 v127, v110, v111
    buffer_store_dwordx4 v[124:127], v220, s[12:15], s64 offen sc1
    s_add_u32 s64, s64, 1024
    s_add_u32 s66, s66, 8
    s_add_u32 s67, s67, 8
    s_add_u32 s65, s65, 2
    s_cmp_lg_u32 s65, 4
    s_cbranch_scc1 G1_nt_14
    s_mov_b32 s67, 0
    s_add_u32 s64, s64, 111616
    v_mov_b32 v226, v140
    v_mov_b32 v227, v141
G1_nt_14:
    s_cmp_lt_u32 s65, 8
    s_cbranch_scc1 G1_ge_13
    s_setprio 0
    s_mov_b32 s8, s26
    s_and_b32 s9, s27, 0xffff
    s_mov_b32 s10, 1835008
    s_mov_b32 s11, 0x20000
    v_lshrrev_b32 v2, 3, v1
    v_bfe_u32 v3, v1, 4, 1
    v_lshlrev_b32 v3, 2, v3
    v_and_b32 v4, 7, v1
    v_xor_b32 v3, v3, v4
    v_mul_u32_u24 v2, 896, v2
    v_lshl_add_u32 v2, v3, 4, v2
    s_lshl_b32 s42, s58, 7
    s_mul_i32 s43, s36, 401408
    s_add_u32 s42, s42, s43
    v_add_u32 v43, s42, v2
    s_mul_i32 s68, s36, 20480
    v_lshrrev_b32 v2, 5, v1
    v_lshlrev_b32 v2, 2, v2
    v_bfe_u32 v3, v1, 2, 2
    v_add_u32 v2, v2, v3
    v_lshlrev_b32 v2, 7, v2
    v_lshrrev_b32 v3, 1, v3
    v_xor_b32 v3, s59, v3
    v_lshl_add_u32 v2, v3, 6, v2
    v_bfe_u32 v3, v1, 4, 1
    v_lshl_add_u32 v2, v3, 5, v2
    v_and_b32 v3, 3, v1
    v_lshl_add_u32 v2, v3, 3, v2
    v_add_u32 v39, s68, v2
    v_xor_b32 v40, 64, v39
    v_lshlrev_b32 v2, 4, v1
    s_mul_i32 s42, s36, 28672
    s_xor_b32 s43, s60, 0
    s_lshl_b32 s44, s57, 1
    s_add_u32 s43, s43, s44
    s_mul_i32 s43, s43, 115712
    s_add_u32 s43, s43, s42
    v_add_u32 v41, s43, v2
    s_xor_b32 s43, s60, 1
    s_lshl_b32 s44, s57, 1
    s_add_u32 s43, s43, s44
    s_mul_i32 s43, s43, 115712
    s_add_u32 s43, s43, s42
    v_add_u32 v42, s43, v2
    v_and_b32 v2, 31, v1
    v_lshrrev_b32 v3, 5, v1
    v_and_b32 v4, 30, v2
    v_lshlrev_b32 v4, 1, v4
    v_mul_u32_u24 v5, 3584, v3
    v_add_u32 v4, v4, v5
    s_mul_i32 s42, s57, 57344
    s_mul_i32 s43, s59, 28672
    s_add_u32 s42, s42, s43
    s_lshl_b32 s43, s58, 7
    s_add_u32 s42, s42, s43
    s_lshl_b32 s43, s60, 6
    s_add_u32 s42, s42, s43
    v_add_u32 v44, s42, v4
    v_add_u32 v51, 7168, v44
    v_add_u32 v52, 14336, v44
    v_add_u32 v53, 21504, v44
    v_add_u32 v4, s61, v2
    v_lshrrev_b32 v4, 1, v4
    v_lshlrev_b32 v4, 3, v4
    v_add_u32 v50, 12716544, v4
    s_lshr_b32 s42, s57, 1
    s_mul_i32 s42, s42, 1792
    s_add_u32 s42, s42, 12779520
    v_min_u32 v4, 13, v1
    v_lshlrev_b32 v4, 7, v4
    v_add_u32 v4, s42, v4
    v_mov_b32 v45, v4
    s_mul_i32 s70, s39, 14
    s_add_u32 s70, s70, s40
    s_lshl_b32 s70, s70, 7
    s_add_u32 s70, s70, 12779520
    v_mov_b32 v54, s28
    v_mov_b32 v55, s29
    v_cmp_eq_u32 vcc, 0, v1
    v_mov_b32 v4, 0x7ff00000
    v_mov_b32 v5, 0
    s_nop 0
    v_cndmask_b32 v56, v4, v5, vcc
    s_waitcnt vmcnt(0)
    s_barrier
    s_cmp_lg_u32 s36, 3
    s_cbranch_scc1 G_pub_15
    buffer_store_dwordx2 v[54:55], v56, s[12:15], s70 offen sc1
G_pub_15:
    s_add_u32 m0, s68, 0
    s_mov_b32 s69, 0
    buffer_load_dwordx4 v43, s[32:35], s69 offen  lds
    s_add_u32 m0, s68, 1024
    s_mov_b32 s69, 7168
    buffer_load_dwordx4 v43, s[32:35], s69 offen  lds
    s_add_u32 m0, s68, 2048
    s_mov_b32 s69, 14336
    buffer_load_dwordx4 v43, s[32:35], s69 offen  lds
    s_add_u32 m0, s68, 3072
    s_mov_b32 s69, 21504
    buffer_load_dwordx4 v43, s[32:35], s69 offen  lds
    s_add_u32 m0, s68, 4096
    s_mov_b32 s69, 28672
    buffer_load_dwordx4 v43, s[32:35], s69 offen  lds
    s_add_u32 m0, s68, 5120
    s_mov_b32 s69, 35840
    buffer_load_dwordx4 v43, s[32:35], s69 offen  lds
    s_add_u32 m0, s68, 6144
    s_mov_b32 s69, 43008
    buffer_load_dwordx4 v43, s[32:35], s69 offen  lds
    s_add_u32 m0, s68, 7168
    s_mov_b32 s69, 50176
    buffer_load_dwordx4 v43, s[32:35], s69 offen  lds
    s_add_u32 m0, s68, 8192
    s_mov_b32 s69, 57344
    buffer_load_dwordx4 v43, s[32:35], s69 offen  lds
    s_add_u32 m0, s68, 9216
    s_mov_b32 s69, 64512
    buffer_load_dwordx4 v43, s[32:35], s69 offen  lds
    s_add_u32 m0, s68, 10240
    s_mov_b32 s69, 71680
    buffer_load_dwordx4 v43, s[32:35], s69 offen  lds
    s_add_u32 m0, s68, 11264
    s_mov_b32 s69, 78848
    buffer_load_dwordx4 v43, s[32:35], s69 offen  lds
    s_add_u32 m0, s68, 12288
    s_mov_b32 s69, 86016
    buffer_load_dwordx4 v43, s[32:35], s69 offen  lds
    s_add_u32 m0, s68, 13312
    s_mov_b32 s69, 93184
    buffer_load_dwordx4 v43, s[32:35], s69 offen  lds
    s_add_u32 m0, s68, 14336
    s_mov_b32 s69, 100352
    buffer_load_dwordx4 v43, s[32:35], s69 offen  lds
    s_add_u32 m0, s68, 15360
    s_mov_b32 s69, 107520
    buffer_load_dwordx4 v43, s[32:35], s69 offen  lds
    v_lshlrev_b32 v60, 16, v22
    v_and_b32 v61, 0xffff0000, v22
    v_lshlrev_b32 v62, 16, v23
    v_and_b32 v63, 0xffff0000, v23
    v_lshlrev_b32 v76, 16, v30
    v_and_b32 v77, 0xffff0000, v30
    v_lshlrev_b32 v78, 16, v31
    v_and_b32 v79, 0xffff0000, v31
    v_add_f32 v60, v60, v76
    v_add_f32 v61, v61, v77
    v_add_f32 v62, v62, v78
    v_add_f32 v63, v63, v79
    v_lshlrev_b32 v64, 16, v24
    v_and_b32 v65, 0xffff0000, v24
    v_lshlrev_b32 v66, 16, v25
    v_and_b32 v67, 0xffff0000, v25
    v_lshlrev_b32 v76, 16, v32
    v_and_b32 v77, 0xffff0000, v32
    v_lshlrev_b32 v78, 16, v33
    v_and_b32 v79, 0xffff0000, v33
    v_add_f32 v64, v64, v76
    v_add_f32 v65, v65, v77
    v_add_f32 v66, v66, v78
    v_add_f32 v67, v67, v79
    v_lshlrev_b32 v68, 16, v26
    v_and_b32 v69, 0xffff0000, v26
    v_lshlrev_b32 v70, 16, v27
    v_and_b32 v71, 0xffff0000, v27
    v_lshlrev_b32 v76, 16, v34
    v_and_b32 v77, 0xffff0000, v34
    v_lshlrev_b32 v78, 16, v35
    v_and_b32 v79, 0xffff0000, v35
    v_add_f32 v68, v68, v76
    v_add_f32 v69, v69, v77
    v_add_f32 v70, v70, v78
    v_add_f32 v71, v71, v79
    v_lshlrev_b32 v72, 16, v28
    v_and_b32 v73, 0xffff0000, v28
    v_lshlrev_b32 v74, 16, v29
    v_and_b32 v75, 0xffff0000, v29
    v_lshlrev_b32 v76, 16, v36
    v_and_b32 v77, 0xffff0000, v36
    v_lshlrev_b32 v78, 16, v37
    v_and_b32 v79, 0xffff0000, v37
    v_add_f32 v72, v72, v76
    v_add_f32 v73, v73, v77
    v_add_f32 v74, v74, v78
    v_add_f32 v75, v75, v79
    v_and_b32 v80, 1, v1
    v_xor_b32 v80, 1, v80
    v_lshlrev_b32 v80, 4, v80
    s_cmp_lg_u32 s36, 0
    s_cbranch_scc1 G_pol_16
    s_mov_b32 s44, 20000
    buffer_load_dwordx2 v[46:47], v45, s[12:15], 0 offen sc1
G_pp_19:
    buffer_load_dwordx2 v[82:83], v45, s[12:15], 0 offen sc1
    s_waitcnt vmcnt(1)
    v_cmp_ne_u32 vcc, s28, v46
    s_mov_b64 s[98:99], vcc
    v_cmp_ne_u32 vcc, s29, v47
    s_or_b64 s[98:99], s[98:99], vcc
    s_cmp_eq_u64 s[98:99], 0
    s_cbranch_scc1 G_ppo_20
    buffer_load_dwordx2 v[46:47], v45, s[12:15], 0 offen sc1
    s_waitcnt vmcnt(1)
    v_cmp_ne_u32 vcc, s28, v82
    s_mov_b64 s[98:99], vcc
    v_cmp_ne_u32 vcc, s29, v83
    s_or_b64 s[98:99], s[98:99], vcc
    s_cmp_eq_u64 s[98:99], 0
    s_cbranch_scc1 G_ppo_20
    s_sub_u32 s44, s44, 1
    s_cmp_lg_u32 s44, 0
    s_cbranch_scc1 G_pp_19
G_ppo_20:
G_pol_16:
    s_barrier
    s_mov_b32 s71, 0
    buffer_load_dwordx4 v[84:87], v41, s[12:15], s71 offen offset:0 sc1
    buffer_load_dwordx4 v[88:91], v42, s[12:15], s71 offen offset:0 sc1
    buffer_load_dwordx4 v[92:95], v41, s[12:15], s71 offen offset:1024 sc1
    buffer_load_dwordx4 v[96:99], v42, s[12:15], s71 offen offset:1024 sc1
    buffer_load_dwordx4 v[100:103], v41, s[12:15], s71 offen offset:2048 sc1
    buffer_load_dwordx4 v[104:107], v42, s[12:15], s71 offen offset:2048 sc1
    buffer_load_dwordx4 v[108:111], v41, s[12:15], s71 offen offset:3072 sc1
    buffer_load_dwordx4 v[112:115], v42, s[12:15], s71 offen offset:3072 sc1
    s_mov_b32 s71, 4096
    buffer_load_dwordx4 v[116:119], v41, s[12:15], s71 offen offset:0 sc1
    buffer_load_dwordx4 v[120:123], v42, s[12:15], s71 offen offset:0 sc1
    buffer_load_dwordx4 v[124:127], v41, s[12:15], s71 offen offset:1024 sc1
    buffer_load_dwordx4 v[128:131], v42, s[12:15], s71 offen offset:1024 sc1
    buffer_load_dwordx4 v[132:135], v41, s[12:15], s71 offen offset:2048 sc1
    buffer_load_dwordx4 v[136:139], v42, s[12:15], s71 offen offset:2048 sc1
    buffer_load_dwordx4 v[140:143], v41, s[12:15], s71 offen offset:3072 sc1
    buffer_load_dwordx4 v[144:147], v42, s[12:15], s71 offen offset:3072 sc1
    s_waitcnt vmcnt(30)
    ds_read_b64_tr_b16 v[148:149], v39 offset:0
    ds_read_b64_tr_b16 v[150:151], v39 offset:1024
    ds_read_b64_tr_b16 v[152:153], v40 offset:0
    ds_read_b64_tr_b16 v[154:155], v40 offset:1024
    s_waitcnt vmcnt(14)
    ds_read_b64_tr_b16 v[156:157], v39 offset:2048
    ds_read_b64_tr_b16 v[158:159], v39 offset:3072
    ds_read_b64_tr_b16 v[160:161], v40 offset:2048
    ds_read_b64_tr_b16 v[162:163], v40 offset:3072
    s_waitcnt lgkmcnt(4)
    v_mfma_f32_32x32x16_bf16 v[164:179], v[148:151], v[84:87], 0
    s_add_u32 m0, s68, 16384
    s_mov_b32 s69, 114688
    buffer_load_dwordx4 v43, s[32:35], s69 offen  lds
    v_mfma_f32_32x32x16_bf16 v[180:195], v[148:151], v[88:91], 0
    s_add_u32 m0, s68, 17408
    s_mov_b32 s69, 121856
    buffer_load_dwordx4 v43, s[32:35], s69 offen  lds
    v_mfma_f32_32x32x16_bf16 v[196:211], v[152:155], v[84:87], 0
    s_mov_b32 s71, 8192
    buffer_load_dwordx4 v[22:25], v41, s[12:15], s71 offen offset:0 sc1
    buffer_load_dwordx4 v[26:29], v42, s[12:15], s71 offen offset:0 sc1
    v_mfma_f32_32x32x16_bf16 v[212:227], v[152:155], v[88:91], 0
    s_waitcnt vmcnt(16)
    ds_read_b64_tr_b16 v[148:149], v39 offset:4096
    ds_read_b64_tr_b16 v[150:151], v39 offset:5120
    ds_read_b64_tr_b16 v[152:153], v40 offset:4096
    ds_read_b64_tr_b16 v[154:155], v40 offset:5120
    s_waitcnt lgkmcnt(4)
    v_mfma_f32_32x32x16_bf16 v[164:179], v[156:159], v[92:95], v[164:179]
    s_add_u32 m0, s68, 18432
    s_mov_b32 s69, 129024
    buffer_load_dwordx4 v43, s[32:35], s69 offen  lds
    v_mfma_f32_32x32x16_bf16 v[180:195], v[156:159], v[96:99], v[180:195]
    s_add_u32 m0, s68, 19456
    s_mov_b32 s69, 136192
    buffer_load_dwordx4 v43, s[32:35], s69 offen  lds
    v_mfma_f32_32x32x16_bf16 v[196:211], v[160:163], v[92:95], v[196:211]
    buffer_load_dwordx4 v[84:87], v41, s[12:15], s71 offen offset:1024 sc1
    buffer_load_dwordx4 v[88:91], v42, s[12:15], s71 offen offset:1024 sc1
    v_mfma_f32_32x32x16_bf16 v[212:227], v[160:163], v[96:99], v[212:227]
    s_waitcnt vmcnt(18)
    ds_read_b64_tr_b16 v[156:157], v39 offset:6144
    ds_read_b64_tr_b16 v[158:159], v39 offset:7168
    ds_read_b64_tr_b16 v[160:161], v40 offset:6144
    ds_read_b64_tr_b16 v[162:163], v40 offset:7168
    s_waitcnt lgkmcnt(4)
    v_mfma_f32_32x32x16_bf16 v[164:179], v[148:151], v[100:103], v[164:179]
    s_add_u32 m0, s68, 0
    s_mov_b32 s69, 143360
    buffer_load_dwordx4 v43, s[32:35], s69 offen  lds
    v_mfma_f32_32x32x16_bf16 v[180:195], v[148:151], v[104:107], v[180:195]
    s_add_u32 m0, s68, 1024
    s_mov_b32 s69, 150528
    buffer_load_dwordx4 v43, s[32:35], s69 offen  lds
    v_mfma_f32_32x32x16_bf16 v[196:211], v[152:155], v[100:103], v[196:211]
    buffer_load_dwordx4 v[92:95], v41, s[12:15], s71 offen offset:2048 sc1
    buffer_load_dwordx4 v[96:99], v42, s[12:15], s71 offen offset:2048 sc1
    v_mfma_f32_32x32x16_bf16 v[212:227], v[152:155], v[104:107], v[212:227]
    s_waitcnt vmcnt(20)
    ds_read_b64_tr_b16 v[148:149], v39 offset:8192
    ds_read_b64_tr_b16 v[150:151], v39 offset:9216
    ds_read_b64_tr_b16 v[152:153], v40 offset:8192
    ds_read_b64_tr_b16 v[154:155], v40 offset:9216
    s_waitcnt lgkmcnt(4)
    v_mfma_f32_32x32x16_bf16 v[164:179], v[156:159], v[108:111], v[164:179]
    s_add_u32 m0, s68, 2048
    s_mov_b32 s69, 157696
    buffer_load_dwordx4 v43, s[32:35], s69 offen  lds
    v_mfma_f32_32x32x16_bf16 v[180:195], v[156:159], v[112:115], v[180:195]
    s_add_u32 m0, s68, 3072
    s_mov_b32 s69, 164864
    buffer_load_dwordx4 v43, s[32:35], s69 offen  lds
    v_mfma_f32_32x32x16_bf16 v[196:211], v[160:163], v[108:111], v[196:211]
    buffer_load_dwordx4 v[100:103], v41, s[12:15], s71 offen offset:3072 sc1
    buffer_load_dwordx4 v[104:107], v42, s[12:15], s71 offen offset:3072 sc1
    v_mfma_f32_32x32x16_bf16 v[212:227], v[160:163], v[112:115], v[212:227]
    s_waitcnt vmcnt(22)
    ds_read_b64_tr_b16 v[156:157], v39 offset:10240
    ds_read_b64_tr_b16 v[158:159], v39 offset:11264
    ds_read_b64_tr_b16 v[160:161], v40 offset:10240
    ds_read_b64_tr_b16 v[162:163], v40 offset:11264
    s_waitcnt lgkmcnt(4)
    v_mfma_f32_32x32x16_bf16 v[164:179], v[148:151], v[116:119], v[164:179]
    s_add_u32 m0, s68, 4096
    s_mov_b32 s69, 172032
    buffer_load_dwordx4 v43, s[32:35], s69 offen  lds
    v_mfma_f32_32x32x16_bf16 v[180:195], v[148:151], v[120:123], v[180:195]
    s_add_u32 m0, s68, 5120
    s_mov_b32 s69, 179200
    buffer_load_dwordx4 v43, s[32:35], s69 offen  lds
    v_mfma_f32_32x32x16_bf16 v[196:211], v[152:155], v[116:119], v[196:211]
    s_mov_b32 s71, 12288
    buffer_load_dwordx4 v[108:111], v41, s[12:15], s71 offen offset:0 sc1
    buffer_load_dwordx4 v[112:115], v42, s[12:15], s71 offen offset:0 sc1
    v_mfma_f32_32x32x16_bf16 v[212:227], v[152:155], v[120:123], v[212:227]
    s_waitcnt vmcnt(24)
    ds_read_b64_tr_b16 v[148:149], v39 offset:12288
    ds_read_b64_tr_b16 v[150:151], v39 offset:13312
    ds_read_b64_tr_b16 v[152:153], v40 offset:12288
    ds_read_b64_tr_b16 v[154:155], v40 offset:13312
    s_waitcnt lgkmcnt(4)
    v_mfma_f32_32x32x16_bf16 v[164:179], v[156:159], v[124:127], v[164:179]
    s_add_u32 m0, s68, 6144
    s_mov_b32 s69, 186368
    buffer_load_dwordx4 v43, s[32:35], s69 offen  lds
    v_mfma_f32_32x32x16_bf16 v[180:195], v[156:159], v[128:131], v[180:195]
    s_add_u32 m0, s68, 7168
    s_mov_b32 s69, 193536
    buffer_load_dwordx4 v43, s[32:35], s69 offen  lds
    v_mfma_f32_32x32x16_bf16 v[196:211], v[160:163], v[124:127], v[196:211]
    buffer_load_dwordx4 v[116:119], v41, s[12:15], s71 offen offset:1024 sc1
    buffer_load_dwordx4 v[120:123], v42, s[12:15], s71 offen offset:1024 sc1
    v_mfma_f32_32x32x16_bf16 v[212:227], v[160:163], v[128:131], v[212:227]
    s_waitcnt vmcnt(26)
    ds_read_b64_tr_b16 v[156:157], v39 offset:14336
    ds_read_b64_tr_b16 v[158:159], v39 offset:15360
    ds_read_b64_tr_b16 v[160:161], v40 offset:14336
    ds_read_b64_tr_b16 v[162:163], v40 offset:15360
    s_waitcnt lgkmcnt(4)
    v_mfma_f32_32x32x16_bf16 v[164:179], v[148:151], v[132:135], v[164:179]
    s_add_u32 m0, s68, 8192
    s_mov_b32 s69, 200704
    buffer_load_dwordx4 v43, s[32:35], s69 offen  lds
    v_mfma_f32_32x32x16_bf16 v[180:195], v[148:151], v[136:139], v[180:195]
    s_add_u32 m0, s68, 9216
    s_mov_b32 s69, 207872
    buffer_load_dwordx4 v43, s[32:35], s69 offen  lds
    v_mfma_f32_32x32x16_bf16 v[196:211], v[152:155], v[132:135], v[196:211]
    buffer_load_dwordx4 v[124:127], v41, s[12:15], s71 offen offset:2048 sc1
    buffer_load_dwordx4 v[128:131], v42, s[12:15], s71 offen offset:2048 sc1
    v_mfma_f32_32x32x16_bf16 v[212:227], v[152:155], v[136:139], v[212:227]
    s_waitcnt vmcnt(26)
    ds_read_b64_tr_b16 v[148:149], v39 offset:16384
    ds_read_b64_tr_b16 v[150:151], v39 offset:17408
    ds_read_b64_tr_b16 v[152:153], v40 offset:16384
    ds_read_b64_tr_b16 v[154:155], v40 offset:17408
    s_waitcnt lgkmcnt(4)
    v_mfma_f32_32x32x16_bf16 v[164:179], v[156:159], v[140:143], v[164:179]
    s_add_u32 m0, s68, 10240
    s_mov_b32 s69, 215040
    buffer_load_dwordx4 v43, s[32:35], s69 offen  lds
    v_mfma_f32_32x32x16_bf16 v[180:195], v[156:159], v[144:147], v[180:195]
    s_add_u32 m0, s68, 11264
    s_mov_b32 s69, 222208
    buffer_load_dwordx4 v43, s[32:35], s69 offen  lds
    v_mfma_f32_32x32x16_bf16 v[196:211], v[160:163], v[140:143], v[196:211]
    buffer_load_dwordx4 v[132:135], v41, s[12:15], s71 offen offset:3072 sc1
    buffer_load_dwordx4 v[136:139], v42, s[12:15], s71 offen offset:3072 sc1
    v_mfma_f32_32x32x16_bf16 v[212:227], v[160:163], v[144:147], v[212:227]
    s_waitcnt vmcnt(26)
    ds_read_b64_tr_b16 v[156:157], v39 offset:18432
    ds_read_b64_tr_b16 v[158:159], v39 offset:19456
    ds_read_b64_tr_b16 v[160:161], v40 offset:18432
    ds_read_b64_tr_b16 v[162:163], v40 offset:19456
    s_waitcnt lgkmcnt(4)
    v_mfma_f32_32x32x16_bf16 v[164:179], v[148:151], v[22:25], v[164:179]
    s_add_u32 m0, s68, 12288
    s_mov_b32 s69, 229376
    buffer_load_dwordx4 v43, s[32:35], s69 offen  lds
    v_mfma_f32_32x32x16_bf16 v[180:195], v[148:151], v[26:29], v[180:195]
    s_add_u32 m0, s68, 13312
    s_mov_b32 s69, 236544
    buffer_load_dwordx4 v43, s[32:35], s69 offen  lds
    v_mfma_f32_32x32x16_bf16 v[196:211], v[152:155], v[22:25], v[196:211]
    s_mov_b32 s71, 16384
    buffer_load_dwordx4 v[140:143], v41, s[12:15], s71 offen offset:0 sc1
    buffer_load_dwordx4 v[144:147], v42, s[12:15], s71 offen offset:0 sc1
    v_mfma_f32_32x32x16_bf16 v[212:227], v[152:155], v[26:29], v[212:227]
    s_waitcnt vmcnt(26)
    ds_read_b64_tr_b16 v[148:149], v39 offset:0
    ds_read_b64_tr_b16 v[150:151], v39 offset:1024
    ds_read_b64_tr_b16 v[152:153], v40 offset:0
    ds_read_b64_tr_b16 v[154:155], v40 offset:1024
    s_waitcnt lgkmcnt(4)
    v_mfma_f32_32x32x16_bf16 v[164:179], v[156:159], v[84:87], v[164:179]
    s_add_u32 m0, s68, 14336
    s_mov_b32 s69, 243712
    buffer_load_dwordx4 v43, s[32:35], s69 offen  lds
    v_mfma_f32_32x32x16_bf16 v[180:195], v[156:159], v[88:91], v[180:195]
    s_add_u32 m0, s68, 15360
    s_mov_b32 s69, 250880
    buffer_load_dwordx4 v43, s[32:35], s69 offen  lds
    v_mfma_f32_32x32x16_bf16 v[196:211], v[160:163], v[84:87], v[196:211]
    buffer_load_dwordx4 v[22:25], v41, s[12:15], s71 offen offset:1024 sc1
    buffer_load_dwordx4 v[26:29], v42, s[12:15], s71 offen offset:1024 sc1
    v_mfma_f32_32x32x16_bf16 v[212:227], v[160:163], v[88:91], v[212:227]
    s_waitcnt vmcnt(26)
    ds_read_b64_tr_b16 v[156:157], v39 offset:2048
    ds_read_b64_tr_b16 v[158:159], v39 offset:3072
    ds_read_b64_tr_b16 v[160:161], v40 offset:2048
    ds_read_b64_tr_b16 v[162:163], v40 offset:3072
    s_waitcnt lgkmcnt(4)
    v_mfma_f32_32x32x16_bf16 v[164:179], v[148:151], v[92:95], v[164:179]
    s_add_u32 m0, s68, 16384
    s_mov_b32 s69, 258048
    buffer_load_dwordx4 v43, s[32:35], s69 offen  lds
    v_mfma_f32_32x32x16_bf16 v[180:195], v[148:151], v[96:99], v[180:195]
    s_add_u32 m0, s68, 17408
    s_mov_b32 s69, 265216
    buffer_load_dwordx4 v43, s[32:35], s69 offen  lds
    v_mfma_f32_32x32x16_bf16 v[196:211], v[152:155], v[92:95], v[196:211]
    buffer_load_dwordx4 v[84:87], v41, s[12:15], s71 offen offset:2048 sc1
    buffer_load_dwordx4 v[88:91], v42, s[12:15], s71 offen offset:2048 sc1
    v_mfma_f32_32x32x16_bf16 v[212:227], v[152:155], v[96:99], v[212:227]
    s_waitcnt vmcnt(26)
    ds_read_b64_tr_b16 v[148:149], v39 offset:4096
    ds_read_b64_tr_b16 v[150:151], v39 offset:5120
    ds_read_b64_tr_b16 v[152:153], v40 offset:4096
    ds_read_b64_tr_b16 v[154:155], v40 offset:5120
    s_waitcnt lgkmcnt(4)
    v_mfma_f32_32x32x16_bf16 v[164:179], v[156:159], v[100:103], v[164:179]
    s_add_u32 m0, s68, 18432
    s_mov_b32 s69, 272384
    buffer_load_dwordx4 v43, s[32:35], s69 offen  lds
    v_mfma_f32_32x32x16_bf16 v[180:195], v[156:159], v[104:107], v[180:195]
    s_add_u32 m0, s68, 19456
    s_mov_b32 s69, 279552
    buffer_load_dwordx4 v43, s[32:35], s69 offen  lds
    v_mfma_f32_32x32x16_bf16 v[196:211], v[160:163], v[100:103], v[196:211]
    buffer_load_dwordx4 v[92:95], v41, s[12:15], s71 offen offset:3072 sc1
    buffer_load_dwordx4 v[96:99], v42, s[12:15], s71 offen offset:3072 sc1
    v_mfma_f32_32x32x16_bf16 v[212:227], v[160:163], v[104:107], v[212:227]
    s_waitcnt vmcnt(26)
    ds_read_b64_tr_b16 v[156:157], v39 offset:6144
    ds_read_b64_tr_b16 v[158:159], v39 offset:7168
    ds_read_b64_tr_b16 v[160:161], v40 offset:6144
    ds_read_b64_tr_b16 v[162:163], v40 offset:7168
    s_waitcnt lgkmcnt(4)
    v_mfma_f32_32x32x16_bf16 v[164:179], v[148:151], v[108:111], v[164:179]
    s_add_u32 m0, s68, 0
    s_mov_b32 s69, 286720
    buffer_load_dwordx4 v43, s[32:35], s69 offen  lds
    v_mfma_f32_32x32x16_bf16 v[180:195], v[148:151], v[112:115], v[180:195]
    s_add_u32 m0, s68, 1024
    s_mov_b32 s69, 293888
    buffer_load_dwordx4 v43, s[32:35], s69 offen  lds
    v_mfma_f32_32x32x16_bf16 v[196:211], v[152:155], v[108:111], v[196:211]
    s_mov_b32 s71, 20480
    buffer_load_dwordx4 v[100:103], v41, s[12:15], s71 offen offset:0 sc1
    buffer_load_dwordx4 v[104:107], v42, s[12:15], s71 offen offset:0 sc1
    v_mfma_f32_32x32x16_bf16 v[212:227], v[152:155], v[112:115], v[212:227]
    s_waitcnt vmcnt(26)
    ds_read_b64_tr_b16 v[148:149], v39 offset:8192
    ds_read_b64_tr_b16 v[150:151], v39 offset:9216
    ds_read_b64_tr_b16 v[152:153], v40 offset:8192
    ds_read_b64_tr_b16 v[154:155], v40 offset:9216
    s_waitcnt lgkmcnt(4)
    v_mfma_f32_32x32x16_bf16 v[164:179], v[156:159], v[116:119], v[164:179]
    s_add_u32 m0, s68, 2048
    s_mov_b32 s69, 301056
    buffer_load_dwordx4 v43, s[32:35], s69 offen  lds
    v_mfma_f32_32x32x16_bf16 v[180:195], v[156:159], v[120:123], v[180:195]
    s_add_u32 m0, s68, 3072
    s_mov_b32 s69, 308224
    buffer_load_dwordx4 v43, s[32:35], s69 offen  lds
    v_mfma_f32_32x32x16_bf16 v[196:211], v[160:163], v[116:119], v[196:211]
    buffer_load_dwordx4 v[108:111], v41, s[12:15], s71 offen offset:1024 sc1
    buffer_load_dwordx4 v[112:115], v42, s[12:15], s71 offen offset:1024 sc1
    v_mfma_f32_32x32x16_bf16 v[212:227], v[160:163], v[120:123], v[212:227]
    s_waitcnt vmcnt(26)
    ds_read_b64_tr_b16 v[156:157], v39 offset:10240
    ds_read_b64_tr_b16 v[158:159], v39 offset:11264
    ds_read_b64_tr_b16 v[160:161], v40 offset:10240
    ds_read_b64_tr_b16 v[162:163], v40 offset:11264
    s_waitcnt lgkmcnt(4)
    v_mfma_f32_32x32x16_bf16 v[164:179], v[148:151], v[124:127], v[164:179]
    s_add_u32 m0, s68, 4096
    s_mov_b32 s69, 315392
    buffer_load_dwordx4 v43, s[32:35], s69 offen  lds
    v_mfma_f32_32x32x16_bf16 v[180:195], v[148:151], v[128:131], v[180:195]
    s_add_u32 m0, s68, 5120
    s_mov_b32 s69, 322560
    buffer_load_dwordx4 v43, s[32:35], s69 offen  lds
    v_mfma_f32_32x32x16_bf16 v[196:211], v[152:155], v[124:127], v[196:211]
    buffer_load_dwordx4 v[116:119], v41, s[12:15], s71 offen offset:2048 sc1
    buffer_load_dwordx4 v[120:123], v42, s[12:15], s71 offen offset:2048 sc1
    v_mfma_f32_32x32x16_bf16 v[212:227], v[152:155], v[128:131], v[212:227]
    s_waitcnt vmcnt(26)
    ds_read_b64_tr_b16 v[148:149], v39 offset:12288
    ds_read_b64_tr_b16 v[150:151], v39 offset:13312
    ds_read_b64_tr_b16 v[152:153], v40 offset:12288
    ds_read_b64_tr_b16 v[154:155], v40 offset:13312
    s_waitcnt lgkmcnt(4)
    v_mfma_f32_32x32x16_bf16 v[164:179], v[156:159], v[132:135], v[164:179]
    s_add_u32 m0, s68, 6144
    s_mov_b32 s69, 329728
    buffer_load_dwordx4 v43, s[32:35], s69 offen  lds
    v_mfma_f32_32x32x16_bf16 v[180:195], v[156:159], v[136:139], v[180:195]
    s_add_u32 m0, s68, 7168
    s_mov_b32 s69, 336896
    buffer_load_dwordx4 v43, s[32:35], s69 offen  lds
    v_mfma_f32_32x32x16_bf16 v[196:211], v[160:163], v[132:135], v[196:211]
    buffer_load_dwordx4 v[124:127], v41, s[12:15], s71 offen offset:3072 sc1
    buffer_load_dwordx4 v[128:131], v42, s[12:15], s71 offen offset:3072 sc1
    v_mfma_f32_32x32x16_bf16 v[212:227], v[160:163], v[136:139], v[212:227]
    s_waitcnt vmcnt(26)
    ds_read_b64_tr_b16 v[156:157], v39 offset:14336
    ds_read_b64_tr_b16 v[158:159], v39 offset:15360
    ds_read_b64_tr_b16 v[160:161], v40 offset:14336
    ds_read_b64_tr_b16 v[162:163], v40 offset:15360
    s_waitcnt lgkmcnt(4)
    v_mfma_f32_32x32x16_bf16 v[164:179], v[148:151], v[140:143], v[164:179]
    s_add_u32 m0, s68, 8192
    s_mov_b32 s69, 344064
    buffer_load_dwordx4 v43, s[32:35], s69 offen  lds
    v_mfma_f32_32x32x16_bf16 v[180:195], v[148:151], v[144:147], v[180:195]
    s_add_u32 m0, s68, 9216
    s_mov_b32 s69, 351232
    buffer_load_dwordx4 v43, s[32:35], s69 offen  lds
    v_mfma_f32_32x32x16_bf16 v[196:211], v[152:155], v[140:143], v[196:211]
    s_mov_b32 s71, 24576
    buffer_load_dwordx4 v[132:135], v41, s[12:15], s71 offen offset:0 sc1
    buffer_load_dwordx4 v[136:139], v42, s[12:15], s71 offen offset:0 sc1
    v_mfma_f32_32x32x16_bf16 v[212:227], v[152:155], v[144:147], v[212:227]
    s_waitcnt vmcnt(26)
    ds_read_b64_tr_b16 v[148:149], v39 offset:16384
    ds_read_b64_tr_b16 v[150:151], v39 offset:17408
    ds_read_b64_tr_b16 v[152:153], v40 offset:16384
    ds_read_b64_tr_b16 v[154:155], v40 offset:17408
    s_waitcnt lgkmcnt(4)
    v_mfma_f32_32x32x16_bf16 v[164:179], v[156:159], v[22:25], v[164:179]
    s_add_u32 m0, s68, 10240
    s_mov_b32 s69, 358400
    buffer_load_dwordx4 v43, s[32:35], s69 offen  lds
    v_mfma_f32_32x32x16_bf16 v[180:195], v[156:159], v[26:29], v[180:195]
    s_add_u32 m0, s68, 11264
    s_mov_b32 s69, 365568
    buffer_load_dwordx4 v43, s[32:35], s69 offen  lds
    v_mfma_f32_32x32x16_bf16 v[196:211], v[160:163], v[22:25], v[196:211]
    buffer_load_dwordx4 v[140:143], v41, s[12:15], s71 offen offset:1024 sc1
    buffer_load_dwordx4 v[144:147], v42, s[12:15], s71 offen offset:1024 sc1
    v_mfma_f32_32x32x16_bf16 v[212:227], v[160:163], v[26:29], v[212:227]
    s_waitcnt vmcnt(26)
    ds_read_b64_tr_b16 v[156:157], v39 offset:18432
    ds_read_b64_tr_b16 v[158:159], v39 offset:19456
    ds_read_b64_tr_b16 v[160:161], v40 offset:18432
    ds_read_b64_tr_b16 v[162:163], v40 offset:19456
    s_waitcnt lgkmcnt(4)
    v_mfma_f32_32x32x16_bf16 v[164:179], v[148:151], v[84:87], v[164:179]
    s_add_u32 m0, s68, 12288
    s_mov_b32 s69, 372736
    buffer_load_dwordx4 v43, s[32:35], s69 offen  lds
    v_mfma_f32_32x32x16_bf16 v[180:195], v[148:151], v[88:91], v[180:195]
    s_add_u32 m0, s68, 13312
    s_mov_b32 s69, 379904
    buffer_load_dwordx4 v43, s[32:35], s69 offen  lds
    v_mfma_f32_32x32x16_bf16 v[196:211], v[152:155], v[84:87], v[196:211]
    buffer_load_dwordx4 v[22:25], v41, s[12:15], s71 offen offset:2048 sc1
    buffer_load_dwordx4 v[26:29], v42, s[12:15], s71 offen offset:2048 sc1
    v_mfma_f32_32x32x16_bf16 v[212:227], v[152:155], v[88:91], v[212:227]
    s_waitcnt vmcnt(26)
    ds_read_b64_tr_b16 v[148:149], v39 offset:0
    ds_read_b64_tr_b16 v[150:151], v39 offset:1024
    ds_read_b64_tr_b16 v[152:153], v40 offset:0
    ds_read_b64_tr_b16 v[154:155], v40 offset:1024
    s_waitcnt lgkmcnt(4)
    v_mfma_f32_32x32x16_bf16 v[164:179], v[156:159], v[92:95], v[164:179]
    s_add_u32 m0, s68, 14336
    s_mov_b32 s69, 387072
    buffer_load_dwordx4 v43, s[32:35], s69 offen  lds
    v_mfma_f32_32x32x16_bf16 v[180:195], v[156:159], v[96:99], v[180:195]
    s_add_u32 m0, s68, 15360
    s_mov_b32 s69, 394240
    buffer_load_dwordx4 v43, s[32:35], s69 offen  lds
    v_mfma_f32_32x32x16_bf16 v[196:211], v[160:163], v[92:95], v[196:211]
    buffer_load_dwordx4 v[84:87], v41, s[12:15], s71 offen offset:3072 sc1
    buffer_load_dwordx4 v[88:91], v42, s[12:15], s71 offen offset:3072 sc1
    v_mfma_f32_32x32x16_bf16 v[212:227], v[160:163], v[96:99], v[212:227]
    buffer_load_dwordx2 v[48:49], v50, s[12:15], 0 offen sc1
    s_waitcnt vmcnt(27)
    ds_read_b64_tr_b16 v[156:157], v39 offset:2048
    ds_read_b64_tr_b16 v[158:159], v39 offset:3072
    ds_read_b64_tr_b16 v[160:161], v40 offset:2048
    ds_read_b64_tr_b16 v[162:163], v40 offset:3072
    s_waitcnt lgkmcnt(4)
    v_mfma_f32_32x32x16_bf16 v[164:179], v[148:151], v[100:103], v[164:179]
    v_mfma_f32_32x32x16_bf16 v[180:195], v[148:151], v[104:107], v[180:195]
    v_mfma_f32_32x32x16_bf16 v[196:211], v[152:155], v[100:103], v[196:211]
    v_mfma_f32_32x32x16_bf16 v[212:227], v[152:155], v[104:107], v[212:227]
    s_waitcnt vmcnt(23)
    ds_read_b64_tr_b16 v[148:149], v39 offset:4096
    ds_read_b64_tr_b16 v[150:151], v39 offset:5120
    ds_read_b64_tr_b16 v[152:153], v40 offset:4096
    ds_read_b64_tr_b16 v[154:155], v40 offset:5120
    s_waitcnt lgkmcnt(4)
    v_mfma_f32_32x32x16_bf16 v[164:179], v[156:159], v[108:111], v[164:179]
    v_mfma_f32_32x32x16_bf16 v[180:195], v[156:159], v[112:115], v[180:195]
    v_mfma_f32_32x32x16_bf16 v[196:211], v[160:163], v[108:111], v[196:211]
    v_mfma_f32_32x32x16_bf16 v[212:227], v[160:163], v[112:115], v[212:227]
    s_waitcnt vmcnt(19)
    ds_read_b64_tr_b16 v[156:157], v39 offset:6144
    ds_read_b64_tr_b16 v[158:159], v39 offset:7168
    ds_read_b64_tr_b16 v[160:161], v40 offset:6144
    ds_read_b64_tr_b16 v[162:163], v40 offset:7168
    s_waitcnt lgkmcnt(4)
    v_mfma_f32_32x32x16_bf16 v[164:179], v[148:151], v[116:119], v[164:179]
    v_mfma_f32_32x32x16_bf16 v[180:195], v[148:151], v[120:123], v[180:195]
    v_mfma_f32_32x32x16_bf16 v[196:211], v[152:155], v[116:119], v[196:211]
    v_mfma_f32_32x32x16_bf16 v[212:227], v[152:155], v[120:123], v[212:227]
    s_waitcnt vmcnt(15)
    ds_read_b64_tr_b16 v[148:149], v39 offset:8192
    ds_read_b64_tr_b16 v[150:151], v39 offset:9216
    ds_read_b64_tr_b16 v[152:153], v40 offset:8192
    ds_read_b64_tr_b16 v[154:155], v40 offset:9216
    s_waitcnt lgkmcnt(4)
    v_mfma_f32_32x32x16_bf16 v[164:179], v[156:159], v[124:127], v[164:179]
    v_mfma_f32_32x32x16_bf16 v[180:195], v[156:159], v[128:131], v[180:195]
    v_mfma_f32_32x32x16_bf16 v[196:211], v[160:163], v[124:127], v[196:211]
    v_mfma_f32_32x32x16_bf16 v[212:227], v[160:163], v[128:131], v[212:227]
    s_waitcnt vmcnt(11)
    ds_read_b64_tr_b16 v[156:157], v39 offset:10240
    ds_read_b64_tr_b16 v[158:159], v39 offset:11264
    ds_read_b64_tr_b16 v[160:161], v40 offset:10240
    ds_read_b64_tr_b16 v[162:163], v40 offset:11264
    s_waitcnt lgkmcnt(4)
    v_mfma_f32_32x32x16_bf16 v[164:179], v[148:151], v[132:135], v[164:179]
    v_mfma_f32_32x32x16_bf16 v[180:195], v[148:151], v[136:139], v[180:195]
    v_mfma_f32_32x32x16_bf16 v[196:211], v[152:155], v[132:135], v[196:211]
    v_mfma_f32_32x32x16_bf16 v[212:227], v[152:155], v[136:139], v[212:227]
    s_waitcnt vmcnt(7)
    ds_read_b64_tr_b16 v[148:149], v39 offset:12288
    ds_read_b64_tr_b16 v[150:151], v39 offset:13312
    ds_read_b64_tr_b16 v[152:153], v40 offset:12288
    ds_read_b64_tr_b16 v[154:155], v40 offset:13312
    s_waitcnt lgkmcnt(4)
    v_mfma_f32_32x32x16_bf16 v[164:179], v[156:159], v[140:143], v[164:179]
    v_mfma_f32_32x32x16_bf16 v[180:195], v[156:159], v[144:147], v[180:195]
    v_mfma_f32_32x32x16_bf16 v[196:211], v[160:163], v[140:143], v[196:211]
    v_mfma_f32_32x32x16_bf16 v[212:227], v[160:163], v[144:147], v[212:227]
    s_waitcnt vmcnt(0)
    v_cmp_ne_u32 vcc, s28, v48
    s_mov_b64 s[98:99], vcc
    v_cmp_ne_u32 vcc, s29, v49
    s_or_b64 s[98:99], s[98:99], vcc
    s_cmp_lg_u64 s[98:99], 0
    s_cselect_b32 s72, 1, 0
    buffer_load_dword v228, v44, s[8:11], 0 offen offset:0 sc1
    buffer_load_dword v229, v44, s[8:11], 0 offen offset:896 sc1
    buffer_load_dword v230, v44, s[8:11], 0 offen offset:1792 sc1
    buffer_load_dword v231, v44, s[8:11], 0 offen offset:2688 sc1
    buffer_load_dword v232, v51, s[8:11], 0 offen offset:0 sc1
    buffer_load_dword v233, v51, s[8:11], 0 offen offset:896 sc1
    buffer_load_dword v234, v51, s[8:11], 0 offen offset:1792 sc1
    buffer_load_dword v235, v51, s[8:11], 0 offen offset:2688 sc1
    buffer_load_dword v236, v52, s[8:11], 0 offen offset:0 sc1
    buffer_load_dword v237, v52, s[8:11], 0 offen offset:896 sc1
    buffer_load_dword v238, v52, s[8:11], 0 offen offset:1792 sc1
    buffer_load_dword v239, v52, s[8:11], 0 offen offset:2688 sc1
    buffer_load_dword v240, v53, s[8:11], 0 offen offset:0 sc1
    buffer_load_dword v241, v53, s[8:11], 0 offen offset:896 sc1
    buffer_load_dword v242, v53, s[8:11], 0 offen offset:1792 sc1
    buffer_load_dword v243, v53, s[8:11], 0 offen offset:2688 sc1
    s_waitcnt vmcnt(19)
    ds_read_b64_tr_b16 v[156:157], v39 offset:14336
    ds_read_b64_tr_b16 v[158:159], v39 offset:15360
    ds_read_b64_tr_b16 v[160:161], v40 offset:14336
    ds_read_b64_tr_b16 v[162:163], v40 offset:15360
    s_waitcnt lgkmcnt(4)
    v_mfma_f32_32x32x16_bf16 v[164:179], v[148:151], v[22:25], v[164:179]
    v_mfma_f32_32x32x16_bf16 v[180:195], v[148:151], v[26:29], v[180:195]
    v_mfma_f32_32x32x16_bf16 v[196:211], v[152:155], v[22:25], v[196:211]
    v_mfma_f32_32x32x16_bf16 v[212:227], v[152:155], v[26:29], v[212:227]
    s_waitcnt vmcnt(17)
    s_waitcnt lgkmcnt(0)
    v_mfma_f32_32x32x16_bf16 v[164:179], v[156:159], v[84:87], v[164:179]
    v_mfma_f32_32x32x16_bf16 v[180:195], v[156:159], v[88:91], v[180:195]
    v_mfma_f32_32x32x16_bf16 v[196:211], v[160:163], v[84:87], v[196:211]
    v_mfma_f32_32x32x16_bf16 v[212:227], v[160:163], v[88:91], v[212:227]
    v_lshlrev_b32 v2, 4, v1
    s_barrier
    s_nop 5
    s_xor_b32 s42, s36, 1
    s_mul_i32 s42, s42, 12288
    s_add_u32 s42, s42, 0
    v_add_u32 v244, s42, v2
    ds_write_b128 v244, v[180:183] offset:0
    ds_write_b128 v244, v[184:187] offset:1024
    ds_write_b128 v244, v[188:191] offset:2048
    ds_write_b128 v244, v[192:195] offset:3072
    s_xor_b32 s42, s36, 2
    s_mul_i32 s42, s42, 12288
    s_add_u32 s42, s42, 4096
    v_add_u32 v244, s42, v2
    ds_write_b128 v244, v[196:199] offset:0
    ds_write_b128 v244, v[200:203] offset:1024
    ds_write_b128 v244, v[204:207] offset:2048
    ds_write_b128 v244, v[208:211] offset:3072
    s_xor_b32 s42, s36, 3
    s_mul_i32 s42, s42, 12288
    s_add_u32 s42, s42, 8192
    v_add_u32 v244, s42, v2
    ds_write_b128 v244, v[212:215] offset:0
    ds_write_b128 v244, v[216:219] offset:1024
    ds_write_b128 v244, v[220:223] offset:2048
    ds_write_b128 v244, v[224:227] offset:3072
    s_mul_i32 s42, s36, 12288
    v_add_u32 v245, s42, v2
    s_cmp_eq_u32 s72, 0
    s_cbranch_scc1 G2_yok_21
    s_waitcnt vmcnt(0)
    buffer_load_dwordx2 v[48:49], v50, s[12:15], 0 offen sc1
    s_waitcnt vmcnt(0)
    s_mov_b32 s44, 20000
TG_l_22:
    v_cmp_ne_u32 vcc, s28, v48
    s_mov_b64 s[98:99], vcc
    v_cmp_ne_u32 vcc, s29, v49
    s_or_b64 s[98:99], s[98:99], vcc
    s_cmp_eq_u64 s[98:99], 0
    s_cbranch_scc1 TG_ok_23
    s_sub_u32 s44, s44, 1
    s_cmp_eq_u32 s44, 0
    s_cbranch_scc1 TG_ok_23
    s_sleep 1
    buffer_load_dwordx2 v[48:49], v50, s[12:15], 0 offen sc1
    s_waitcnt vmcnt(0)
    s_branch TG_l_22
TG_ok_23:
    buffer_load_dword v228, v44, s[8:11], 0 offen offset:0 sc1
    buffer_load_dword v229, v44, s[8:11], 0 offen offset:896 sc1
    buffer_load_dword v230, v44, s[8:11], 0 offen offset:1792 sc1
    buffer_load_dword v231, v44, s[8:11], 0 offen offset:2688 sc1
    buffer_load_dword v232, v51, s[8:11], 0 offen offset:0 sc1
    buffer_load_dword v233, v51, s[8:11], 0 offen offset:896 sc1
    buffer_load_dword v234, v51, s[8:11], 0 offen offset:1792 sc1
    buffer_load_dword v235, v51, s[8:11], 0 offen offset:2688 sc1
    buffer_load_dword v236, v52, s[8:11], 0 offen offset:0 sc1
    buffer_load_dword v237, v52, s[8:11], 0 offen offset:896 sc1
    buffer_load_dword v238, v52, s[8:11], 0 offen offset:1792 sc1
    buffer_load_dword v239, v52, s[8:11], 0 offen offset:2688 sc1
    buffer_load_dword v240, v53, s[8:11], 0 offen offset:0 sc1
    buffer_load_dword v241, v53, s[8:11], 0 offen offset:896 sc1
    buffer_load_dword v242, v53, s[8:11], 0 offen offset:1792 sc1
    buffer_load_dword v243, v53, s[8:11], 0 offen offset:2688 sc1
G2_yok_21:
    s_waitcnt vmcnt(0) lgkmcnt(0)
    s_barrier
    ds_read_b128 v[84:87], v245 offset:0
    ds_read_b128 v[88:91], v245 offset:1024
    ds_read_b128 v[92:95], v245 offset:2048
    ds_read_b128 v[96:99], v245 offset:3072
    ds_read_b128 v[100:103], v245 offset:4096
    ds_read_b128 v[104:107], v245 offset:5120
    ds_read_b128 v[108:111], v245 offset:6144
    ds_read_b128 v[112:115], v245 offset:7168
    ds_read_b128 v[116:119], v245 offset:8192
    ds_read_b128 v[120:123], v245 offset:9216
    ds_read_b128 v[124:127], v245 offset:10240
    ds_read_b128 v[128:131], v245 offset:11264
    s_waitcnt vmcnt(0)
    v_lshlrev_b32 v228, v80, v228
    v_and_b32 v228, 0xffff0000, v228
    v_lshlrev_b32 v229, v80, v229
    v_and_b32 v229, 0xffff0000, v229
    v_pk_add_f32 v[60:61], v[60:61], v[228:229]
    v_lshlrev_b32 v230, v80, v230
    v_and_b32 v230, 0xffff0000, v230
    v_lshlrev_b32 v231, v80, v231
    v_and_b32 v231, 0xffff0000, v231
    v_pk_add_f32 v[62:63], v[62:63], v[230:231]
    v_lshlrev_b32 v232, v80, v232
    v_and_b32 v232, 0xffff0000, v232
    v_lshlrev_b32 v233, v80, v233
    v_and_b32 v233, 0xffff0000, v233
    v_pk_add_f32 v[64:65], v[64:65], v[232:233]
    v_lshlrev_b32 v234, v80, v234
    v_and_b32 v234, 0xffff0000, v234
    v_lshlrev_b32 v235, v80, v235
    v_and_b32 v235, 0xffff0000, v235
    v_pk_add_f32 v[66:67], v[66:67], v[234:235]
    v_lshlrev_b32 v236, v80, v236
    v_and_b32 v236, 0xffff0000, v236
    v_lshlrev_b32 v237, v80, v237
    v_and_b32 v237, 0xffff0000, v237
    v_pk_add_f32 v[68:69], v[68:69], v[236:237]
    v_lshlrev_b32 v238, v80, v238
    v_and_b32 v238, 0xffff0000, v238
    v_lshlrev_b32 v239, v80, v239
    v_and_b32 v239, 0xffff0000, v239
    v_pk_add_f32 v[70:71], v[70:71], v[238:239]
    v_lshlrev_b32 v240, v80, v240
    v_and_b32 v240, 0xffff0000, v240
    v_lshlrev_b32 v241, v80, v241
    v_and_b32 v241, 0xffff0000, v241
    v_pk_add_f32 v[72:73], v[72:73], v[240:241]
    v_lshlrev_b32 v242, v80, v242
    v_and_b32 v242, 0xffff0000, v242
    v_lshlrev_b32 v243, v80, v243
    v_and_b32 v243, 0xffff0000, v243
    v_pk_add_f32 v[74:75], v[74:75], v[242:243]
    v_pk_add_f32 v[164:165], v[164:165], v[60:61]
    v_pk_add_f32 v[166:167], v[166:167], v[62:63]
    v_pk_add_f32 v[168:169], v[168:169], v[64:65]
    v_pk_add_f32 v[170:171], v[170:171], v[66:67]
    v_pk_add_f32 v[172:173], v[172:173], v[68:69]
    v_pk_add_f32 v[174:175], v[174:175], v[70:71]
    v_pk_add_f32 v[176:177], v[176:177], v[72:73]
    v_pk_add_f32 v[178:179], v[178:179], v[74:75]
    s_waitcnt lgkmcnt(8)
    v_pk_add_f32 v[164:165], v[164:165], v[84:85]
    v_pk_add_f32 v[166:167], v[166:167], v[86:87]
    v_pk_add_f32 v[168:169], v[168:169], v[88:89]
    v_pk_add_f32 v[170:171], v[170:171], v[90:91]
    v_pk_add_f32 v[172:173], v[172:173], v[92:93]
    v_pk_add_f32 v[174:175], v[174:175], v[94:95]
    v_pk_add_f32 v[176:177], v[176:177], v[96:97]
    v_pk_add_f32 v[178:179], v[178:179], v[98:99]
    s_waitcnt lgkmcnt(4)
    v_pk_add_f32 v[164:165], v[164:165], v[100:101]
    v_pk_add_f32 v[166:167], v[166:167], v[102:103]
    v_pk_add_f32 v[168:169], v[168:169], v[104:105]
    v_pk_add_f32 v[170:171], v[170:171], v[106:107]
    v_pk_add_f32 v[172:173], v[172:173], v[108:109]
    v_pk_add_f32 v[174:175], v[174:175], v[110:111]
    v_pk_add_f32 v[176:177], v[176:177], v[112:113]
    v_pk_add_f32 v[178:179], v[178:179], v[114:115]
    s_waitcnt lgkmcnt(0)
    v_pk_add_f32 v[164:165], v[164:165], v[116:117]
    v_pk_add_f32 v[166:167], v[166:167], v[118:119]
    v_pk_add_f32 v[168:169], v[168:169], v[120:121]
    v_pk_add_f32 v[170:171], v[170:171], v[122:123]
    v_pk_add_f32 v[172:173], v[172:173], v[124:125]
    v_pk_add_f32 v[174:175], v[174:175], v[126:127]
    v_pk_add_f32 v[176:177], v[176:177], v[128:129]
    v_pk_add_f32 v[178:179], v[178:179], v[130:131]
    v_cvt_pk_bf16_f32 v60, v164, v165
    v_cvt_pk_bf16_f32 v61, v166, v167
    v_cvt_pk_bf16_f32 v62, v168, v169
    v_cvt_pk_bf16_f32 v63, v170, v171
    v_cvt_pk_bf16_f32 v64, v172, v173
    v_cvt_pk_bf16_f32 v65, v174, v175
    v_cvt_pk_bf16_f32 v66, v176, v177
    v_cvt_pk_bf16_f32 v67, v178, v179
    v_and_b32 v2, 31, v1
    s_lshl_b32 s42, s60, 5
    v_add_u32 v2, s42, v2
    v_mul_u32_u24 v2, 144, v2
    v_lshrrev_b32 v3, 5, v1
    v_lshl_add_u32 v2, v3, 3, v2
    s_lshl_b32 s42, s59, 6
    s_add_u32 s42, s42, 49152
    v_add_u32 v2, s42, v2
    ds_write_b64 v2, v[60:61] offset:0
    ds_write_b64 v2, v[62:63] offset:16
    ds_write_b64 v2, v[64:65] offset:32
    ds_write_b64 v2, v[66:67] offset:48
    v_lshrrev_b32 v3, 3, v1
    s_lshl_b32 s42, s36, 4
    v_add_u32 v3, s42, v3
    v_and_b32 v4, 7, v1
    v_mul_u32_u24 v5, 144, v3
    v_lshl_add_u32 v5, v4, 4, v5
    v_add_u32 v5, 49152, v5
    v_mul_u32_u24 v3, 896, v3
    v_lshl_add_u32 v3, v4, 4, v3
    s_mul_i32 s42, s57, 57344
    s_lshl_b32 s43, s58, 7
    s_add_u32 s42, s42, s43
    s_add_u32 s43, s42, 7168
    s_waitcnt lgkmcnt(0)
    s_barrier
    ds_read_b128 v[60:63], v5
    ds_read_b128 v[64:67], v5 offset:1152
    s_waitcnt lgkmcnt(1)
    buffer_store_dwordx4 v[60:63], v3, s[8:11], s42 offen sc1
    s_waitcnt lgkmcnt(0)
    buffer_store_dwordx4 v[64:67], v3, s[8:11], s43 offen sc1
    s_waitcnt vmcnt(0)
    s_branch M_END
R_AUX:
    s_load_dwordx2 s[44:45], s[0:1], 8
    s_load_dwordx2 s[48:49], s[0:1], 16
    s_load_dwordx2 s[52:53], s[0:1], 24
    s_load_dwordx2 s[56:57], s[0:1], 32
    s_load_dwordx2 s[60:61], s[0:1], 40
    s_load_dwordx2 s[64:65], s[0:1], 48
    s_load_dwordx2 s[68:69], s[0:1], 56
    s_load_dwordx2 s[70:71], s[0:1], 64
    s_load_dwordx2 s[4:5], s[0:1], 128
    s_load_dwordx2 s[8:9], s[0:1], 120
    s_load_dwordx2 s[32:33], s[0:1], 96
    s_load_dwordx2 s[36:37], s[0:1], 112
    v_lshrrev_b32 v2, 6, v0
    v_and_b32 v1, 63, v0
    v_readfirstlane_b32 s14, v2
    s_sub_u32 s15, s2, 32
    s_and_b32 s18, s15, 7
    s_mul_i32 s18, s18, 28
    s_lshr_b32 s15, s15, 3
    s_add_u32 s15, s15, s18
    s_lshr_b32 s16, s14, 1
    s_and_b32 s17, s14, 1
    s_lshl_b32 s18, s15, 10
    s_lshl_b32 s19, s14, 8
    s_add_u32 s18, s18, s19
    v_lshlrev_b32 v9, 1, v1
    v_add_u32 v9, s18, v9
    s_waitcnt lgkmcnt(0)
    s_and_b32 s45, s45, 0xffff
    s_mov_b32 s46, 229376
    s_mov_b32 s47, 0x20000
    s_and_b32 s49, s49, 0xffff
    s_mov_b32 s50, 229376
    s_mov_b32 s51, 0x20000
    s_and_b32 s53, s53, 0xffff
    s_mov_b32 s54, 229376
    s_mov_b32 s55, 0x20000
    s_and_b32 s57, s57, 0xffff
    s_mov_b32 s58, 229376
    s_mov_b32 s59, 0x20000
    s_and_b32 s61, s61, 0xffff
    s_mov_b32 s62, 229376
    s_mov_b32 s63, 0x20000
    s_and_b32 s65, s65, 0xffff
    s_mov_b32 s66, 229376
    s_mov_b32 s67, 0x20000
    buffer_load_ushort v10, v9, s[44:47], 0 offen offset:0 nt
    buffer_load_ushort v11, v9, s[48:51], 0 offen offset:0 nt
    buffer_load_ushort v12, v9, s[52:55], 0 offen offset:0 nt
    buffer_load_ushort v13, v9, s[56:59], 0 offen offset:0 nt
    buffer_load_ushort v14, v9, s[60:63], 0 offen offset:0 nt
    buffer_load_ushort v15, v9, s[64:67], 0 offen offset:0 nt
    buffer_load_ushort v16, v9, s[44:47], 0 offen offset:128 nt
    buffer_load_ushort v17, v9, s[48:51], 0 offen offset:128 nt
    buffer_load_ushort v18, v9, s[52:55], 0 offen offset:128 nt
    buffer_load_ushort v19, v9, s[56:59], 0 offen offset:128 nt
    buffer_load_ushort v20, v9, s[60:63], 0 offen offset:128 nt
    buffer_load_ushort v21, v9, s[64:67], 0 offen offset:128 nt
    s_lshl_b32 s18, s15, 2
    s_load_dword s24, s[68:69], s18
    s_load_dword s25, s[70:71], s18
    s_and_b32 s5, s5, 0xffff
    s_mov_b32 s6, 13631488
    s_mov_b32 s7, 0x20000
    s_and_b32 s33, s33, 0xffff
    s_mov_b32 s34, 1605632
    s_mov_b32 s35, 0x20000
    s_and_b32 s37, s37, 0xffff
    s_mov_b32 s38, 1835008
    s_mov_b32 s39, 0x20000
    s_lshl_b32 s18, s15, 1
    s_add_u32 s18, s18, s16
    s_and_b32 s19, s18, 63
    s_mul_i32 s19, s19, 896
    s_lshr_b32 s18, s18, 6
    s_lshl_b32 s18, s18, 7
    s_add_u32 s40, s18, s19
    s_and_b32 s9, s9, 0xffff
    s_mov_b32 s10, 256
    s_mov_b32 s11, 0x20000
    v_mov_b32 v8, 0
    buffer_load_dwordx2 v[6:7], v8, s[8:11], 0 offen sc1
    v_mov_b32 v24, 0
    v_mov_b32 v25, 0
    v_mov_b32 v26, 0
    v_mov_b32 v27, 0
    v_and_b32 v3, 31, v1
    v_lshlrev_b32 v3, 4, v3
    v_lshrrev_b32 v4, 5, v1
    v_mul_u32_u24 v4, 4608, v4
    v_add_u32 v3, v3, v4
    ds_write_b128 v3, v[24:27] offset:0
    s_mul_i32 s18, s14, 9216
    s_add_u32 s18, s18, 9216
    v_lshlrev_b32 v28, 2, v1
    v_add_u32 v28, s18, v28
    v_and_b32 v2, 15, v1
    v_mul_u32_u24 v2, 288, v2
    v_lshrrev_b32 v3, 4, v1
    v_lshl_add_u32 v2, v3, 4, v2
    v_add_u32 v29, s18, v2
    s_waitcnt lgkmcnt(0)
    s_lshl_b32 s18, s16, 4
    s_lshr_b32 s26, s24, s18
    s_lshl_b32 s26, s26, 16
    s_lshr_b32 s27, s25, s18
    s_lshl_b32 s27, s27, 16
    v_mov_b32 v36, s26
    v_mul_f32 v36, 0x3fb8aa3b, v36
    v_exp_f32 v36, v36
    s_nop 0
    v_cvt_pk_bf16_f32 v36, v36, v36
    v_lshlrev_b32 v36, 16, v36
    v_mov_b32 v40, 0
    v_mov_b32 v41, 0
    v_mov_b32 v42, 0
    v_mov_b32 v43, 0
    v_mov_b32 v44, 0
    v_mov_b32 v45, 0
    v_mov_b32 v46, 0
    v_mov_b32 v47, 0
    v_mov_b32 v48, 0
    v_mov_b32 v49, 0
    v_mov_b32 v50, 0
    v_mov_b32 v51, 0
    v_mov_b32 v52, 0
    v_mov_b32 v53, 0
    v_mov_b32 v54, 0
    v_mov_b32 v55, 0
    s_mov_b32 s28, 0
    s_waitcnt vmcnt(1)
    v_lshlrev_b32 v30, 16, v10
    v_lshlrev_b32 v31, 16, v11
    v_lshlrev_b32 v32, 16, v12
    v_lshlrev_b32 v33, 16, v13
    v_lshlrev_b32 v34, 16, v14
    v_lshlrev_b32 v35, 16, v15
AX_A_24:
    v_mul_f32 v56, v36, v30
    v_mul_f32 v57, v36, v31
    v_mul_f32 v32, v36, v32
    v_mul_f32 v33, v36, v33
    v_mul_f32 v56, 0x3fb8aa3b, v56
    v_mul_f32 v57, 0x3e22f983, v57
    v_mul_f32 v2, v35, v33
    v_mul_f32 v59, v35, v32
    v_fma_f32 v58, v34, v32, -v2
    v_fmac_f32 v59, v34, v33
    v_mul_f32 v2, 0x41000000, v56
    v_mul_f32 v3, 0x41000000, v57
    v_exp_f32 v2, v2
    v_fract_f32 v3, v3
    s_nop 0
    v_cos_f32 v60, v3
    v_sin_f32 v61, v3
    s_nop 0
    v_mul_f32 v60, v60, v2
    v_mul_f32 v61, v61, v2
    v_exp_f32 v2, v56
    v_fract_f32 v3, v57
    s_nop 0
    v_cos_f32 v62, v3
    v_sin_f32 v63, v3
    s_nop 0
    v_mul_f32 v62, v62, v2
    v_mul_f32 v63, v63, v2
    v_mul_f32 v2, 0x43800000, v56
    v_mul_f32 v3, 0x43800000, v57
    v_exp_f32 v2, v2
    v_fract_f32 v3, v3
    s_nop 0
    v_cos_f32 v64, v3
    v_sin_f32 v65, v3
    s_nop 0
    v_mul_f32 v64, v64, v2
    v_mul_f32 v65, v65, v2
    v_mul_f32 v68, v61, v61
    v_mul_f32 v69, v63, v63
    v_mul_f32 v71, v61, v60
    v_mul_f32 v83, v63, v62
    v_fma_f32 v70, v60, v60, -v68
    v_fma_f32 v82, v62, v62, -v69
    v_fmac_f32 v71, v60, v61
    v_fmac_f32 v83, v62, v63
    v_mov_b32 v66, 0x00003f80
    v_cvt_pk_bf16_f32 v67, v60, v61
    ds_write2_b32 v28, v66, v67 offset1:72
    v_mul_f32 v68, v71, v61
    v_mul_f32 v69, v83, v83
    v_mul_f32 v77, v71, v60
    v_mul_f32 v85, v83, v82
    v_fma_f32 v76, v70, v60, -v68
    v_fma_f32 v84, v82, v82, -v69
    v_fmac_f32 v77, v70, v61
    v_fmac_f32 v85, v82, v83
    v_mov_b32 v72, v70
    v_mov_b32 v73, v71
    v_cvt_pk_bf16_f32 v66, v70, v71
    v_cvt_pk_bf16_f32 v67, v76, v77
    v_add_u32 v80, 576, v28
    s_mov_b32 s19, 7
    ds_write2_b32 v80, v66, v67 offset1:72
    v_add_u32 v80, 576, v80
AX_B_25:
    v_mul_f32 v68, v73, v71
    v_mul_f32 v69, v77, v71
    v_mul_f32 v75, v73, v70
    v_mul_f32 v79, v77, v70
    v_fma_f32 v74, v72, v70, -v68
    v_fma_f32 v78, v76, v70, -v69
    v_fmac_f32 v75, v72, v71
    v_fmac_f32 v79, v76, v71
    v_cvt_pk_bf16_f32 v66, v74, v75
    v_cvt_pk_bf16_f32 v67, v78, v79
    ds_write2_b32 v80, v66, v67 offset0:0 offset1:72
    v_mul_f32 v68, v75, v71
    v_mul_f32 v69, v79, v71
    v_mul_f32 v73, v75, v70
    v_mul_f32 v77, v79, v70
    v_fma_f32 v72, v74, v70, -v68
    v_fma_f32 v76, v78, v70, -v69
    v_fmac_f32 v73, v74, v71
    v_fmac_f32 v77, v78, v71
    v_cvt_pk_bf16_f32 v66, v72, v73
    v_cvt_pk_bf16_f32 v67, v76, v77
    s_sub_u32 s19, s19, 1
    ds_write2_b32 v80, v66, v67 offset0:144 offset1:216
    v_add_u32 v80, 1152, v80
    s_cmp_lg_u32 s19, 0
    s_cbranch_scc1 AX_B_25
    ds_read_b128 v[88:91], v29 offset:0
    ds_read_b128 v[92:95], v29 offset:64
    ds_read_b128 v[96:99], v29 offset:128
    ds_read_b128 v[100:103], v29 offset:192
    ds_read_b128 v[104:107], v29 offset:4608
    ds_read_b128 v[108:111], v29 offset:4672
    ds_read_b128 v[112:115], v29 offset:4736
    ds_read_b128 v[116:119], v29 offset:4800
    v_cvt_pk_bf16_f32 v152, v58, -v59
    v_mul_f32 v69, v59, v65
    ds_write_b32 v28, v152 offset:0
    v_mul_f32 v155, v59, v64
    v_mul_f32 v68, v59, v63
    v_fma_f32 v154, v58, v64, -v69
    v_mul_f32 v75, v59, v62
    v_fmac_f32 v155, v58, v65
    v_fma_f32 v74, v58, v62, -v68
    v_cvt_pk_bf16_f32 v153, v154, -v155
    v_fmac_f32 v75, v58, v63
    ds_write_b32 v28, v153 offset:2304
    v_cvt_pk_bf16_f32 v152, v74, -v75
    v_mul_f32 v69, v155, v83
    ds_write_b32 v28, v152 offset:288
    v_mul_f32 v77, v155, v82
    v_mul_f32 v68, v75, v63
    v_fma_f32 v76, v154, v82, -v69
    v_mul_f32 v73, v75, v62
    v_fmac_f32 v77, v154, v83
    v_fma_f32 v72, v74, v62, -v68
    v_cvt_pk_bf16_f32 v153, v76, -v77
    v_fmac_f32 v73, v74, v63
    ds_write_b32 v28, v153 offset:2592
    v_cvt_pk_bf16_f32 v152, v72, -v73
    v_mul_f32 v69, v77, v83
    ds_write_b32 v28, v152 offset:576
    v_mul_f32 v79, v77, v82
    v_mul_f32 v68, v73, v63
    v_fma_f32 v78, v76, v82, -v69
    v_mul_f32 v75, v73, v62
    v_fmac_f32 v79, v76, v83
    v_fma_f32 v74, v72, v62, -v68
    v_cvt_pk_bf16_f32 v153, v78, -v79
    v_fmac_f32 v75, v72, v63
    ds_write_b32 v28, v153 offset:2880
    v_cvt_pk_bf16_f32 v152, v74, -v75
    v_mul_f32 v69, v79, v83
    ds_write_b32 v28, v152 offset:864
    v_mul_f32 v77, v79, v82
    v_mul_f32 v68, v75, v63
    v_fma_f32 v76, v78, v82, -v69
    v_mul_f32 v73, v75, v62
    v_fmac_f32 v77, v78, v83
    v_fma_f32 v72, v74, v62, -v68
    v_cvt_pk_bf16_f32 v153, v76, -v77
    v_fmac_f32 v73, v74, v63
    ds_write_b32 v28, v153 offset:3168
    v_cvt_pk_bf16_f32 v152, v72, -v73
    v_mul_f32 v69, v155, v65
    ds_write_b32 v28, v152 offset:1152
    v_mul_f32 v157, v155, v64
    v_mul_f32 v68, v73, v63
    v_fma_f32 v156, v154, v64, -v69
    v_mul_f32 v75, v73, v62
    v_fmac_f32 v157, v154, v65
    v_fma_f32 v74, v72, v62, -v68
    v_cvt_pk_bf16_f32 v153, v156, -v157
    v_fmac_f32 v75, v72, v63
    ds_write_b32 v28, v153 offset:3456
    v_cvt_pk_bf16_f32 v152, v74, -v75
    ds_write_b32 v28, v152 offset:1440
    v_mul_f32 v68, v75, v63
    v_mul_f32 v73, v75, v62
    v_fma_f32 v72, v74, v62, -v68
    v_fmac_f32 v73, v74, v63
    v_cvt_pk_bf16_f32 v152, v72, -v73
    ds_write_b32 v28, v152 offset:1728
    v_mul_f32 v68, v73, v63
    v_mul_f32 v75, v73, v62
    v_fma_f32 v74, v72, v62, -v68
    v_fmac_f32 v75, v72, v63
    v_cvt_pk_bf16_f32 v152, v74, -v75
    ds_write_b32 v28, v152 offset:2016
    v_mul_f32 v68, v157, v85
    v_mul_f32 v69, v157, v65
    v_mul_f32 v73, v157, v84
    v_mul_f32 v155, v157, v64
    v_fma_f32 v72, v156, v84, -v68
    v_fma_f32 v154, v156, v64, -v69
    v_fmac_f32 v73, v156, v85
    v_fmac_f32 v155, v156, v65
    v_cvt_pk_bf16_f32 v152, v72, -v73
    v_cvt_pk_bf16_f32 v153, v154, -v155
    ds_write_b32 v28, v152 offset:3744
    ds_write_b32 v28, v153 offset:4032
    v_mul_f32 v68, v155, v85
    v_mul_f32 v69, v155, v65
    v_mul_f32 v75, v155, v84
    v_mul_f32 v157, v155, v64
    v_fma_f32 v74, v154, v84, -v68
    v_fma_f32 v156, v154, v64, -v69
    v_fmac_f32 v75, v154, v85
    v_fmac_f32 v157, v154, v65
    v_cvt_pk_bf16_f32 v152, v74, -v75
    v_cvt_pk_bf16_f32 v153, v156, -v157
    ds_write_b32 v28, v152 offset:4320
    ds_write_b32 v28, v153 offset:4608
    v_mul_f32 v69, v157, v65
    v_mul_f32 v77, v157, v64
    v_fma_f32 v76, v156, v64, -v69
    v_fmac_f32 v77, v156, v65
    v_cvt_pk_bf16_f32 v153, v76, -v77
    ds_write_b32 v28, v153 offset:4896
    v_mul_f32 v69, v77, v65
    v_mul_f32 v79, v77, v64
    v_fma_f32 v78, v76, v64, -v69
    v_fmac_f32 v79, v76, v65
    v_cvt_pk_bf16_f32 v153, v78, -v79
    ds_write_b32 v28, v153 offset:5184
    v_mul_f32 v69, v79, v65
    v_mul_f32 v77, v79, v64
    v_fma_f32 v76, v78, v64, -v69
    v_fmac_f32 v77, v78, v65
    v_cvt_pk_bf16_f32 v153, v76, -v77
    ds_write_b32 v28, v153 offset:5472
    v_mul_f32 v69, v77, v65
    v_mul_f32 v79, v77, v64
    v_fma_f32 v78, v76, v64, -v69
    v_fmac_f32 v79, v76, v65
    v_cvt_pk_bf16_f32 v153, v78, -v79
    ds_write_b32 v28, v153 offset:5760
    ds_read_b128 v[120:123], v29 offset:0
    ds_read_b128 v[124:127], v29 offset:64
    ds_read_b128 v[128:131], v29 offset:128
    ds_read_b128 v[132:135], v29 offset:192
    ds_read_b128 v[136:139], v29 offset:4608
    ds_read_b128 v[140:143], v29 offset:4672
    ds_read_b128 v[144:147], v29 offset:4736
    ds_read_b128 v[148:151], v29 offset:4800
    v_lshlrev_b32 v30, 16, v16
    v_lshlrev_b32 v31, 16, v17
    v_lshlrev_b32 v32, 16, v18
    v_lshlrev_b32 v33, 16, v19
    v_lshlrev_b32 v34, 16, v20
    v_lshlrev_b32 v35, 16, v21
    s_waitcnt lgkmcnt(0)
    v_mfma_f32_16x16x32_bf16 v[40:43], v[120:123], v[88:91], v[40:43]
    v_mfma_f32_16x16x32_bf16 v[44:47], v[120:123], v[104:107], v[44:47]
    v_mfma_f32_16x16x32_bf16 v[48:51], v[136:139], v[88:91], v[48:51]
    v_mfma_f32_16x16x32_bf16 v[52:55], v[136:139], v[104:107], v[52:55]
    v_mfma_f32_16x16x32_bf16 v[40:43], v[124:127], v[92:95], v[40:43]
    v_mfma_f32_16x16x32_bf16 v[44:47], v[124:127], v[108:111], v[44:47]
    v_mfma_f32_16x16x32_bf16 v[48:51], v[140:143], v[92:95], v[48:51]
    v_mfma_f32_16x16x32_bf16 v[52:55], v[140:143], v[108:111], v[52:55]
    v_mfma_f32_16x16x32_bf16 v[40:43], v[128:131], v[96:99], v[40:43]
    v_mfma_f32_16x16x32_bf16 v[44:47], v[128:131], v[112:115], v[44:47]
    v_mfma_f32_16x16x32_bf16 v[48:51], v[144:147], v[96:99], v[48:51]
    v_mfma_f32_16x16x32_bf16 v[52:55], v[144:147], v[112:115], v[52:55]
    v_mfma_f32_16x16x32_bf16 v[40:43], v[132:135], v[100:103], v[40:43]
    v_mfma_f32_16x16x32_bf16 v[44:47], v[132:135], v[116:119], v[44:47]
    v_mfma_f32_16x16x32_bf16 v[48:51], v[148:151], v[100:103], v[48:51]
    v_mfma_f32_16x16x32_bf16 v[52:55], v[148:151], v[116:119], v[52:55]
    s_cmp_lg_u32 s28, 0
    s_cbranch_scc1 AX_w2_26
    s_cmp_lg_u32 s14, 3
    s_cbranch_scc1 AX_w2_26
    v_lshlrev_b32 v22, 7, v1
    v_cmp_gt_u32 vcc, 56, v1
    v_mov_b32 v2, 0x7ff00000
    s_mul_i32 s20, s15, 7168
    v_cndmask_b32 v22, v2, v22, vcc
    buffer_load_dword v23, v22, s[32:35], s20 offen
AX_w2_26:
    s_cmp_lg_u32 s28, 0
    s_cbranch_scc1 AX_nn2
    v_mov_b32 v8, 0
    buffer_load_dwordx2 v[6:7], v8, s[8:11], 0 offen sc1
AX_nn2:
    s_add_u32 s28, s28, 1
    s_cmp_lt_u32 s28, 2
    s_cbranch_scc1 AX_A_24
    s_waitcnt vmcnt(0)
    s_mov_b32 s20, 20000
NC_l_27:
    v_readfirstlane_b32 s12, v6
    v_readfirstlane_b32 s13, v7
    s_nop 1
    s_cmp_lg_u32 s12, 0
    s_cbranch_scc1 NC_ok_28
    s_sub_u32 s20, s20, 1
    s_cmp_eq_u32 s20, 0
    s_cbranch_scc1 NC_ok_28
    s_sleep 1
    buffer_load_dwordx2 v[6:7], v8, s[8:11], 0 offen sc1
    s_waitcnt vmcnt(0)
    s_branch NC_l_27
NC_ok_28:
    s_mul_i32 s18, s14, 9216
    s_add_u32 s18, s18, 9216
    v_lshlrev_b32 v2, 4, v1
    v_add_u32 v3, s18, v2
    s_nop 3
    ds_write_b128 v3, v[40:43] offset:0
    ds_write_b128 v3, v[44:47] offset:1024
    ds_write_b128 v3, v[48:51] offset:2048
    ds_write_b128 v3, v[52:55] offset:3072
    s_waitcnt lgkmcnt(0)
    s_barrier
    v_lshlrev_b32 v2, 4, v1
    s_lshl_b32 s18, s16, 1
    s_mul_i32 s18, s18, 9216
    s_lshl_b32 s19, s17, 11
    s_add_u32 s18, s18, s19
    s_add_u32 s18, s18, 9216
    v_add_u32 v3, s18, v2
    ds_read_b128 v[120:123], v3 offset:0
    ds_read_b128 v[124:127], v3 offset:9216
    ds_read_b128 v[128:131], v3 offset:1024
    ds_read_b128 v[132:135], v3 offset:10240
    v_and_b32 v3, 15, v1
    v_mul_u32_u24 v3, 80, v3
    v_lshrrev_b32 v4, 4, v1
    v_lshl_add_u32 v3, v4, 3, v3
    s_lshl_b32 s18, s17, 5
    s_mul_i32 s19, s16, 2560
    s_add_u32 s18, s18, s19
    s_add_u32 s18, s18, 46080
    v_add_u32 v3, s18, v3
    s_waitcnt lgkmcnt(0)
    v_add_f32 v120, v120, v124
    v_add_f32 v121, v121, v125
    v_add_f32 v122, v122, v126
    v_add_f32 v123, v123, v127
    v_add_f32 v128, v128, v132
    v_add_f32 v129, v129, v133
    v_add_f32 v130, v130, v134
    v_add_f32 v131, v131, v135
    v_mov_b32 v4, s27
    v_lshl_add_u32 v5, v1, 1, s17
    v_cmp_eq_u32 vcc, 0, v5
    v_mov_b32 v5, 0
    s_nop 0
    v_cndmask_b32 v4, v5, v4, vcc
    v_add_f32 v120, v120, v4
    v_cvt_pk_bf16_f32 v120, v120, v121
    v_cvt_pk_bf16_f32 v121, v122, v123
    ds_write_b64 v3, v[120:121] offset:0
    v_cvt_pk_bf16_f32 v128, v128, v129
    v_cvt_pk_bf16_f32 v129, v130, v131
    ds_write_b64 v3, v[128:129] offset:1280
    v_and_b32 v32, 31, v1
    v_lshlrev_b32 v32, 3, v32
    v_add_u32 v32, 12716288, v32
    buffer_load_dwordx2 v[30:31], v32, s[4:7], 0 offen sc1
    s_waitcnt lgkmcnt(0)
    s_barrier
    s_mov_b32 s41, 235669504
    v_mov_b32 v33, 319951120
    s_mul_i32 s42, s16, 2560
    s_add_u32 s42, s42, 46080
    s_mul_i32 s43, s16, 16640
    s_add_u32 s43, s43, 9216
    s_lshl_b32 s18, s17, 7
    v_add_u32 v34, s18, v1
    v_add_u32 v2, 0, v34
    v_lshrrev_b32 v3, 5, v2
    v_perm_b32 v3, v33, s41, v3
    v_and_b32 v3, 0x18, v3
    v_and_b32 v4, 31, v2
    v_mul_u32_u24 v4, 80, v4
    v_lshl_add_u32 v4, v3, 1, v4
    v_add_u32 v4, s42, v4
    ds_read_b128 v[36:39], v4
    v_add_u32 v2, 1, v2
    v_lshrrev_b32 v4, 5, v2
    v_min_u32 v5, 7, v4
    v_perm_b32 v5, v33, s41, v5
    v_and_b32 v5, 0xff, v5
    v_lshrrev_b32 v4, 3, v4
    v_add_u32 v5, v5, v4
    v_and_b32 v2, 31, v2
    v_mul_u32_u24 v2, 80, v2
    v_lshl_add_u32 v2, v5, 1, v2
    v_add_u32 v2, s42, v2
    ds_read_u16 v44, v2
    v_add_u32 v2, 64, v34
    v_lshrrev_b32 v3, 5, v2
    v_perm_b32 v3, v33, s41, v3
    v_and_b32 v3, 0x18, v3
    v_and_b32 v4, 31, v2
    v_mul_u32_u24 v4, 80, v4
    v_lshl_add_u32 v4, v3, 1, v4
    v_add_u32 v4, s42, v4
    ds_read_b128 v[40:43], v4
    v_add_u32 v2, 1, v2
    v_lshrrev_b32 v4, 5, v2
    v_min_u32 v5, 7, v4
    v_perm_b32 v5, v33, s41, v5
    v_and_b32 v5, 0xff, v5
    v_lshrrev_b32 v4, 3, v4
    v_add_u32 v5, v5, v4
    v_and_b32 v2, 31, v2
    v_mul_u32_u24 v2, 80, v2
    v_lshl_add_u32 v2, v5, 1, v2
    v_add_u32 v2, s42, v2
    ds_read_u16 v45, v2
    v_bfe_u32 v2, v1, 1, 2
    v_mul_u32_u24 v2, 4160, v2
    v_and_b32 v4, 1, v1
    v_lshl_add_u32 v2, v4, 4, v2
    v_add_u32 v2, s43, v2
    ds_write_b128 v2, v[24:27]
    s_mov_b32 s44, 0x01000100
    s_mov_b32 s45, 0x03020302
    s_mov_b32 s46, 0x05040302
    s_mov_b32 s47, 0x05040100
    s_waitcnt lgkmcnt(1)
    s_cmp_eq_u32 s17, 1
    s_cbranch_scc1 AX_w1_29
    v_perm_b32 v48, v36, v36, s44
    v_perm_b32 v49, v37, v36, s46
    v_perm_b32 v50, v37, v37, s44
    v_perm_b32 v51, v44, v37, s46
    v_cmp_gt_u32 vcc, 32, v1
    s_nop 1
    v_cndmask_b32 v48, v48, v36, vcc
    v_cndmask_b32 v49, v49, v37, vcc
    v_cndmask_b32 v50, v50, v38, vcc
    v_cndmask_b32 v51, v51, v39, vcc
    v_cndmask_b32 v2, v43, v42, vcc
    v_perm_b32 v52, v2, v2, s44
    v_mov_b32 v53, v2
    v_perm_b32 v54, v2, v2, s45
    v_perm_b32 v55, v45, v45, s44
    s_branch AX_we_30
AX_w1_29:
    v_lshrrev_b32 v3, 5, v1
    v_lshlrev_b32 v3, 4, v3
    v_and_b32 v4, 1, v1
    v_cmp_eq_u32 vcc, 0, v4
    v_lshrrev_b32 v2, v3, v36
    v_perm_b32 v48, v2, v2, s44
    v_mov_b32 v49, v48
    v_perm_b32 v51, v44, v44, s44
    v_cndmask_b32 v5, v44, v2, vcc
    v_perm_b32 v50, v44, v5, s47
    v_lshrrev_b32 v2, v3, v41
    v_perm_b32 v52, v2, v2, s44
    v_mov_b32 v53, v52
    v_perm_b32 v55, v45, v45, s44
    v_cndmask_b32 v5, v45, v2, vcc
    v_perm_b32 v54, v45, v5, s47
AX_we_30:
    v_lshlrev_b32 v56, 4, v34
    v_add_u32 v56, s43, v56
    v_add_u32 v56, 32, v56
    ds_write_b128 v56, v[48:51]
    ds_write_b128 v56, v[52:55] offset:1024
    s_waitcnt vmcnt(0)
    s_mov_b32 s20, 20000
TG_l_31:
    v_cmp_ne_u32 vcc, s12, v30
    s_mov_b64 s[98:99], vcc
    v_cmp_ne_u32 vcc, s13, v31
    s_or_b64 s[98:99], s[98:99], vcc
    s_cmp_eq_u64 s[98:99], 0
    s_cbranch_scc1 TG_ok_32
    s_sub_u32 s20, s20, 1
    s_cmp_eq_u32 s20, 0
    s_cbranch_scc1 TG_ok_32
    s_sleep 1
    buffer_load_dwordx2 v[30:31], v32, s[4:7], 0 offen sc1
    s_waitcnt vmcnt(0)
    s_branch TG_l_31
TG_ok_32:
    s_lshl_b32 s18, s17, 6
    v_add_u32 v2, s18, v1
    v_lshrrev_b32 v3, 2, v2
    v_mul_u32_u24 v3, 57344, v3
    v_and_b32 v4, 3, v2
    v_lshl_add_u32 v3, v4, 5, v3
    buffer_load_dwordx4 v[60:63], v3, s[36:39], s40 offen offset:0 sc1
    buffer_load_dwordx4 v[64:67], v3, s[36:39], s40 offen offset:16 sc1
    v_lshlrev_b32 v68, 5, v2
    s_mul_i32 s18, s16, 4608
    s_add_u32 s18, s18, 512
    v_add_u32 v68, s18, v68
    s_waitcnt lgkmcnt(0)
    s_barrier
    v_add_u32 v2, -8, v56
    ds_read_b64 v[70:71], v2
    ds_read_b64 v[72:73], v2 offset:1024
    v_alignbit_b32 v77, v49, v48, 16
    v_alignbit_b32 v78, v50, v49, 16
    v_alignbit_b32 v79, v51, v50, 16
    v_mov_b32 v81, v48
    v_mov_b32 v82, v49
    v_mov_b32 v83, v50
    v_mov_b32 v86, v77
    v_mov_b32 v87, v78
    s_waitcnt lgkmcnt(0)
    v_alignbit_b32 v76, v48, v71, 16
    v_mov_b32 v80, v71
    v_alignbit_b32 v84, v71, v70, 16
    v_mov_b32 v85, v76
    ds_write_b128 v56, v[76:79] offset:4160
    ds_write_b128 v56, v[80:83] offset:8320
    ds_write_b128 v56, v[84:87] offset:12480
    v_alignbit_b32 v89, v53, v52, 16
    v_alignbit_b32 v90, v54, v53, 16
    v_alignbit_b32 v91, v55, v54, 16
    v_mov_b32 v93, v52
    v_mov_b32 v94, v53
    v_mov_b32 v95, v54
    v_mov_b32 v98, v89
    v_mov_b32 v99, v90
    v_alignbit_b32 v88, v52, v73, 16
    v_mov_b32 v92, v73
    v_alignbit_b32 v96, v73, v72, 16
    v_mov_b32 v97, v88
    ds_write_b128 v56, v[88:91] offset:5184
    ds_write_b128 v56, v[92:95] offset:9344
    ds_write_b128 v56, v[96:99] offset:13504
    s_waitcnt vmcnt(0)
    ds_write_b128 v68, v[60:63]
    ds_write_b128 v68, v[64:67] offset:16
    v_bfe_u32 v2, v1, 2, 2
    v_mul_u32_u24 v2, 4160, v2
    v_and_b32 v3, 3, v1
    v_lshl_add_u32 v2, v3, 3, v2
    v_lshrrev_b32 v3, 5, v1
    v_lshl_add_u32 v2, v3, 5, v2
    v_bfe_u32 v4, v1, 4, 1
    v_lshlrev_b32 v4, 4, v4
    v_sub_u32 v2, v2, v4
    s_lshl_b32 s18, s17, 8
    s_add_u32 s19, s18, s43
    s_add_u32 s19, s19, 24
    v_add_u32 v100, s19, v2
    v_and_b32 v2, 15, v1
    v_lshlrev_b32 v2, 5, v2
    v_lshlrev_b32 v3, 5, v3
    v_sub_u32 v2, v2, v3
    v_add_u32 v2, v2, v4
    s_mul_i32 s19, s16, 4608
    s_add_u32 s19, s19, 512
    s_sub_u32 s19, s19, s18
    v_add_u32 v101, s19, v2
    v_bfe_u32 v4, v1, 2, 2
    v_mul_u32_u24 v4, 57344, v4
    v_and_b32 v5, 3, v1
    v_lshl_add_u32 v4, v5, 5, v4
    v_lshrrev_b32 v5, 4, v1
    v_lshl_add_u32 v102, v5, 3, v4
    v_lshlrev_b32 v2, 4, v1
    s_lshl_b32 s18, s14, 12
    s_add_u32 s18, s18, 51200
    v_add_u32 v103, s18, v2
    s_xor_b32 s18, s14, 1
    s_lshl_b32 s18, s18, 12
    s_add_u32 s18, s18, 51200
    v_add_u32 v104, s18, v2
    v_mov_b32 v172, 0
    v_mov_b32 v173, 0
    v_mov_b32 v174, 0
    v_mov_b32 v175, 0
    v_mov_b32 v176, 0
    v_mov_b32 v177, 0
    v_mov_b32 v178, 0
    v_mov_b32 v179, 0
    v_mov_b32 v180, 0
    v_mov_b32 v181, 0
    v_mov_b32 v182, 0
    v_mov_b32 v183, 0
    v_mov_b32 v184, 0
    v_mov_b32 v185, 0
    v_mov_b32 v186, 0
    v_mov_b32 v187, 0
    v_mov_b32 v188, 0
    v_mov_b32 v189, 0
    v_mov_b32 v190, 0
    v_mov_b32 v191, 0
    v_mov_b32 v192, 0
    v_mov_b32 v193, 0
    v_mov_b32 v194, 0
    v_mov_b32 v195, 0
    v_mov_b32 v196, 0
    v_mov_b32 v197, 0
    v_mov_b32 v198, 0
    v_mov_b32 v199, 0
    v_mov_b32 v200, 0
    v_mov_b32 v201, 0
    v_mov_b32 v202, 0
    v_mov_b32 v203, 0
    s_mov_b32 s48, 4
    s_waitcnt lgkmcnt(0)
    s_barrier
AX_C_33:
    ds_read_b64_tr_b16 v[108:109], v100 offset:8
    ds_read_b64_tr_b16 v[110:111], v100 offset:0
    ds_read_b128 v[140:143], v101 offset:0
    ds_read_b64_tr_b16 v[112:113], v100 offset:520
    ds_read_b64_tr_b16 v[114:115], v100 offset:512
    ds_read_b128 v[144:147], v101 offset:512
    ds_read_b64_tr_b16 v[116:117], v100 offset:1032
    ds_read_b64_tr_b16 v[118:119], v100 offset:1024
    ds_read_b128 v[148:151], v101 offset:1024
    s_waitcnt lgkmcnt(6)
    v_mfma_f32_16x16x32_bf16 v[172:175], v[108:111], v[140:143], v[172:175]
    ds_read_b64_tr_b16 v[120:121], v100 offset:1544
    ds_read_b64_tr_b16 v[122:123], v100 offset:1536
    ds_read_b128 v[152:155], v101 offset:1536
    s_waitcnt lgkmcnt(6)
    v_mfma_f32_16x16x32_bf16 v[176:179], v[112:115], v[140:143], v[176:179]
    v_mfma_f32_16x16x32_bf16 v[180:183], v[112:115], v[144:147], v[180:183]
    v_mfma_f32_16x16x32_bf16 v[176:179], v[108:111], v[144:147], v[176:179]
    ds_read_b64_tr_b16 v[124:125], v100 offset:2056
    ds_read_b64_tr_b16 v[126:127], v100 offset:2048
    ds_read_b128 v[156:159], v101 offset:2048
    s_waitcnt lgkmcnt(6)
    v_mfma_f32_16x16x32_bf16 v[180:183], v[116:119], v[140:143], v[180:183]
    v_mfma_f32_16x16x32_bf16 v[184:187], v[116:119], v[144:147], v[184:187]
    v_mfma_f32_16x16x32_bf16 v[188:191], v[116:119], v[148:151], v[188:191]
    v_mfma_f32_16x16x32_bf16 v[180:183], v[108:111], v[148:151], v[180:183]
    v_mfma_f32_16x16x32_bf16 v[184:187], v[112:115], v[148:151], v[184:187]
    ds_read_b64_tr_b16 v[128:129], v100 offset:2568
    ds_read_b64_tr_b16 v[130:131], v100 offset:2560
    ds_read_b128 v[160:163], v101 offset:2560
    s_waitcnt lgkmcnt(6)
    v_mfma_f32_16x16x32_bf16 v[184:187], v[120:123], v[140:143], v[184:187]
    v_mfma_f32_16x16x32_bf16 v[188:191], v[120:123], v[144:147], v[188:191]
    v_mfma_f32_16x16x32_bf16 v[192:195], v[120:123], v[148:151], v[192:195]
    v_mfma_f32_16x16x32_bf16 v[196:199], v[120:123], v[152:155], v[196:199]
    v_mfma_f32_16x16x32_bf16 v[184:187], v[108:111], v[152:155], v[184:187]
    v_mfma_f32_16x16x32_bf16 v[188:191], v[112:115], v[152:155], v[188:191]
    v_mfma_f32_16x16x32_bf16 v[192:195], v[116:119], v[152:155], v[192:195]
    ds_read_b64_tr_b16 v[132:133], v100 offset:3080
    ds_read_b64_tr_b16 v[134:135], v100 offset:3072
    ds_read_b128 v[164:167], v101 offset:3072
    s_waitcnt lgkmcnt(6)
    v_mfma_f32_16x16x32_bf16 v[188:191], v[124:127], v[140:143], v[188:191]
    v_mfma_f32_16x16x32_bf16 v[192:195], v[124:127], v[144:147], v[192:195]
    v_mfma_f32_16x16x32_bf16 v[196:199], v[124:127], v[148:151], v[196:199]
    v_mfma_f32_16x16x32_bf16 v[200:203], v[124:127], v[152:155], v[200:203]
    v_mfma_f32_16x16x32_bf16 v[188:191], v[108:111], v[156:159], v[188:191]
    v_mfma_f32_16x16x32_bf16 v[192:195], v[112:115], v[156:159], v[192:195]
    v_mfma_f32_16x16x32_bf16 v[196:199], v[116:119], v[156:159], v[196:199]
    v_mfma_f32_16x16x32_bf16 v[200:203], v[120:123], v[156:159], v[200:203]
    ds_read_b64_tr_b16 v[136:137], v100 offset:3592
    ds_read_b64_tr_b16 v[138:139], v100 offset:3584
    ds_read_b128 v[168:171], v101 offset:3584
    s_waitcnt lgkmcnt(6)
    v_mfma_f32_16x16x32_bf16 v[192:195], v[128:131], v[140:143], v[192:195]
    v_mfma_f32_16x16x32_bf16 v[196:199], v[128:131], v[144:147], v[196:199]
    v_mfma_f32_16x16x32_bf16 v[200:203], v[128:131], v[148:151], v[200:203]
    v_mfma_f32_16x16x32_bf16 v[192:195], v[108:111], v[160:163], v[192:195]
    v_mfma_f32_16x16x32_bf16 v[196:199], v[112:115], v[160:163], v[196:199]
    v_mfma_f32_16x16x32_bf16 v[200:203], v[116:119], v[160:163], v[200:203]
    s_waitcnt lgkmcnt(3)
    v_mfma_f32_16x16x32_bf16 v[196:199], v[132:135], v[140:143], v[196:199]
    v_mfma_f32_16x16x32_bf16 v[200:203], v[132:135], v[144:147], v[200:203]
    v_mfma_f32_16x16x32_bf16 v[196:199], v[108:111], v[164:167], v[196:199]
    v_mfma_f32_16x16x32_bf16 v[200:203], v[112:115], v[164:167], v[200:203]
    s_waitcnt lgkmcnt(0)
    v_mfma_f32_16x16x32_bf16 v[200:203], v[136:139], v[140:143], v[200:203]
    v_mfma_f32_16x16x32_bf16 v[200:203], v[108:111], v[168:171], v[200:203]
    v_add_u32 v100, 64, v100
    v_add_u32 v101, -64, v101
    s_sub_u32 s48, s48, 1
    s_cmp_lg_u32 s48, 0
    s_cbranch_scc1 AX_C_33
    s_nop 7
    s_cmp_eq_u32 s17, 1
    s_cbranch_scc1 AX_x1_34
    ds_write_b128 v103, v[188:191] offset:0
    ds_write_b128 v103, v[192:195] offset:1024
    ds_write_b128 v103, v[196:199] offset:2048
    ds_write_b128 v103, v[200:203] offset:3072
    v_mov_b32 v204, v172
    v_mov_b32 v205, v173
    v_mov_b32 v206, v174
    v_mov_b32 v207, v175
    v_mov_b32 v208, v176
    v_mov_b32 v209, v177
    v_mov_b32 v210, v178
    v_mov_b32 v211, v179
    v_mov_b32 v212, v180
    v_mov_b32 v213, v181
    v_mov_b32 v214, v182
    v_mov_b32 v215, v183
    v_mov_b32 v216, v184
    v_mov_b32 v217, v185
    v_mov_b32 v218, v186
    v_mov_b32 v219, v187
    s_branch AX_xe_35
AX_x1_34:
    ds_write_b128 v103, v[172:175] offset:0
    ds_write_b128 v103, v[176:179] offset:1024
    ds_write_b128 v103, v[180:183] offset:2048
    ds_write_b128 v103, v[184:187] offset:3072
    v_mov_b32 v204, v188
    v_mov_b32 v205, v189
    v_mov_b32 v206, v190
    v_mov_b32 v207, v191
    v_mov_b32 v208, v192
    v_mov_b32 v209, v193
    v_mov_b32 v210, v194
    v_mov_b32 v211, v195
    v_mov_b32 v212, v196
    v_mov_b32 v213, v197
    v_mov_b32 v214, v198
    v_mov_b32 v215, v199
    v_mov_b32 v216, v200
    v_mov_b32 v217, v201
    v_mov_b32 v218, v202
    v_mov_b32 v219, v203
AX_xe_35:
    s_mul_i32 s19, s17, 917504
    s_add_u32 s49, s40, s19
    s_waitcnt lgkmcnt(0)
    s_barrier
    ds_read_b128 v[108:111], v104 offset:0
    ds_read_b128 v[112:115], v104 offset:1024
    ds_read_b128 v[116:119], v104 offset:2048
    ds_read_b128 v[120:123], v104 offset:3072
    s_waitcnt lgkmcnt(3)
    v_add_f32 v108, v108, v204
    v_add_f32 v109, v109, v205
    v_add_f32 v110, v110, v206
    v_add_f32 v111, v111, v207
    v_cvt_pk_bf16_f32 v108, v108, v109
    v_cvt_pk_bf16_f32 v109, v110, v111
    buffer_store_dwordx2 v[108:109], v102, s[36:39], s49 offen sc1
    s_add_u32 s49, s49, 229376
    s_waitcnt lgkmcnt(2)
    v_add_f32 v112, v112, v208
    v_add_f32 v113, v113, v209
    v_add_f32 v114, v114, v210
    v_add_f32 v115, v115, v211
    v_cvt_pk_bf16_f32 v112, v112, v113
    v_cvt_pk_bf16_f32 v113, v114, v115
    buffer_store_dwordx2 v[112:113], v102, s[36:39], s49 offen sc1
    s_add_u32 s49, s49, 229376
    s_waitcnt lgkmcnt(1)
    v_add_f32 v116, v116, v212
    v_add_f32 v117, v117, v213
    v_add_f32 v118, v118, v214
    v_add_f32 v119, v119, v215
    v_cvt_pk_bf16_f32 v116, v116, v117
    v_cvt_pk_bf16_f32 v117, v118, v119
    buffer_store_dwordx2 v[116:117], v102, s[36:39], s49 offen sc1
    s_add_u32 s49, s49, 229376
    s_waitcnt lgkmcnt(0)
    v_add_f32 v120, v120, v216
    v_add_f32 v121, v121, v217
    v_add_f32 v122, v122, v218
    v_add_f32 v123, v123, v219
    v_cvt_pk_bf16_f32 v120, v120, v121
    v_cvt_pk_bf16_f32 v121, v122, v123
    buffer_store_dwordx2 v[120:121], v102, s[36:39], s49 offen sc1
    s_waitcnt vmcnt(0)
    s_barrier
    s_lshl_b32 s18, s15, 3
    s_add_u32 s18, s18, 12716544
    s_cmp_lg_u32 s14, 0
    s_cbranch_scc1 FL_s_36
    v_mov_b32 v2, s12
    v_mov_b32 v3, s13
    v_cmp_eq_u32 vcc, 0, v1
    v_mov_b32 v4, 0x7ff00000
    v_mov_b32 v5, 0
    s_nop 0
    v_cndmask_b32 v4, v4, v5, vcc
    buffer_store_dwordx2 v[2:3], v4, s[4:7], s18 offen sc1
FL_s_36:
    s_waitcnt vmcnt(0)
    s_branch M_END
M_END:
    s_endpgm
.section .rodata,"a"
.p2align 6
.amdhsa_kernel parallel_sum__ssm_conv_s4__dense_activation_gelu__prompt_kernel
  .amdhsa_next_free_vgpr 246
  .amdhsa_next_free_sgpr 100
  .amdhsa_accum_offset 248
  .amdhsa_group_segment_fixed_size 0
  .amdhsa_kernarg_size 136
  .amdhsa_user_sgpr_count 2
  .amdhsa_user_sgpr_kernarg_segment_ptr 1
  .amdhsa_system_sgpr_workgroup_id_x 1
  .amdhsa_float_denorm_mode_32 3
.end_amdhsa_kernel
```
